```python
import torch

def _softmax(x, axis=-1):
    return torch.softmax(x, dim=axis)
def _gelu(x):
    return torch.nn.functional.gelu(x, approximate="tanh")
def _silu(x):
    return torch.nn.functional.silu(x)
def _sigmoid(x):
    return torch.sigmoid(x)
def _layernorm(x, axis=-1, eps=1e-5):
    m = x.mean(dim=axis, keepdim=True)
    v = x.var(dim=axis, keepdim=True, unbiased=False)
    return (x - m) / torch.sqrt(v + eps)
def _scatter_add(tgt, idx, src, axis=0):
    return tgt.clone().index_add_(axis, idx, src)
def _segment_sum(src, seg, n):
    out = torch.zeros((n,) + src.shape[1:], dtype=src.dtype)
    return out.index_add_(0, seg, src)
def _pad(x, pw):
    flat = tuple(v for pair in reversed(pw) for v in pair)
    return torch.nn.functional.pad(x, flat)

kernel_name = 'interleave_layers__sliding_block__moe_arch_mod__prompt'

def setup_inputs():

    _w = (lambda a: (lambda t: t.to(torch.bfloat16) if t.is_floating_point() else t)(torch.as_tensor(a)))
    def _A_setup():
        B, S, D = 1, 2048, 640
        return {
            "x": _w((lambda *s: torch.randn(*s, dtype=torch.bfloat16) * 0.05)(B, S, D)),
            "wqkv": _w((lambda *s: torch.randn(*s, dtype=torch.bfloat16) * 0.05)(D, 3 * D)),
            "wo": _w((lambda *s: torch.randn(*s, dtype=torch.bfloat16) * 0.05)(D, D)),
        }
    _A_in = _A_setup()

    def _B_setup():
        B, S, D, F, C = 1, 2048, 640, 1536, 8
        return {
            "x": _w((lambda *s: torch.randn(*s, dtype=torch.bfloat16) * 0.05)(B, S, D)),
            "w_r": _w((lambda *s: torch.randn(*s, dtype=torch.bfloat16) * 0.05)(D)),
            "w_gate": _w((lambda *s: torch.randn(*s, dtype=torch.bfloat16) * 0.05)(D, F)),
            "w_up": _w((lambda *s: torch.randn(*s, dtype=torch.bfloat16) * 0.05)(D, F)),
            "w_down": _w((lambda *s: torch.randn(*s, dtype=torch.bfloat16) * 0.05)(F, D)),
        }
    _B_in = _B_setup()

    return {
        "A_x": _A_in["x"],
        "A_wqkv": _A_in["wqkv"],
        "A_wo": _A_in["wo"],
        "B_x": _B_in["x"],
        "B_w_r": _B_in["w_r"],
        "B_w_gate": _B_in["w_gate"],
        "B_w_up": _B_in["w_up"],
        "B_w_down": _B_in["w_down"],
    }

def reference(A_x, A_wqkv, A_wo, B_x, B_w_r, B_w_gate, B_w_up, B_w_down):
    def _A_ref(x, wqkv, wo):
        B, S, D = x.shape
        H = 32; Dh = D // H; W = 256
        qkv = (lambda x, *d: x.permute(*d))((x @ wqkv).reshape(B, S, 3, H, Dh), 2, 0, 3, 1, 4)
        q, k, v = qkv[0], qkv[1], qkv[2]
        scores = torch.einsum("bhqd,bhkd->bhqk", q, k) * (Dh ** -0.5)
        idx = torch.arange(S)
        mask = (idx[:, None] - idx[None, :] >= 0) & (idx[:, None] - idx[None, :] < W)
        scores = torch.where(mask[None, None], scores, -1e9)
        p = _softmax(scores, axis=-1)
        o = torch.einsum("bhqk,bhkd->bhqd", p, v)
        return (lambda x, *d: x.permute(*d))(o, 0, 2, 1, 3).reshape(B, S, D) @ wo

    def _B_ref(x, w_r, w_gate, w_up, w_down):
        B, S, D = x.shape
        C = 8
        r = x @ w_r
        idx = torch.argsort(-r, axis=-1)[:, :C]
        idx_e = (lambda x, n, axis: torch.repeat_interleave(x, n, dim=axis))(idx.reshape(B, C, 1), D, axis=2)
        x_sel = (lambda x, i, axis: torch.take_along_dim(x, i, dim=axis))(x, idx_e, axis=1)
        g = _silu(x_sel @ w_gate)
        u = x_sel @ w_up
        y = (g * u) @ w_down
        r_sel = _sigmoid((lambda x, i, axis: torch.take_along_dim(x, i, dim=axis))(r, idx, axis=1))
        y = y * r_sel.reshape(B, C, 1)
        b_off = (torch.arange(B) * S).reshape(B, 1)
        flat_idx = (idx + b_off).reshape(B * C)
        zero = (x * 0.0).reshape(B * S, D)
        upd = _scatter_add(zero, flat_idx, y.reshape(B * C, D), axis=0)
        return x + upd.reshape(B, S, D)

    x = A_x
    x = x + _A_ref(_layernorm(x, axis=-1), A_wqkv, A_wo)
    x = x + _B_ref(_layernorm(x, axis=-1), B_w_r, B_w_gate, B_w_up, B_w_down)
    x = x + _A_ref(_layernorm(x, axis=-1), A_wqkv, A_wo)
    x = x + _B_ref(_layernorm(x, axis=-1), B_w_r, B_w_gate, B_w_up, B_w_down)
    return x
```

```asm
; @launch grid=(256,1,1) block=(576,1,1) lds=160768
.amdgcn_target "amdgcn-amd-amdhsa--gfx950"
.text
.p2align 8
Lcode_start:
.p2align 8
.globl interleave_layers__sliding_block__moe_arch_mod__prompt_kernel
.type interleave_layers__sliding_block__moe_arch_mod__prompt_kernel,@function
interleave_layers__sliding_block__moe_arch_mod__prompt_kernel:
    s_load_dwordx2 s[28:29], s[0:1], 80
    s_mov_b32 s30, 0x4000000
    s_mov_b32 s31, 0x20000
    s_load_dwordx2 s[20:21], s[0:1], 0
    s_mov_b32 s22, 0x280000
    s_mov_b32 s23, 0x20000
    s_cmp_ge_u32 s2, 256
    s_cbranch_scc1 Lend
    v_lshrrev_b32 v1, 6, v0
    v_and_b32 v0, 63, v0
    v_readfirstlane_b32 s10, v1
    s_mov_b32 s96, 0
    s_mov_b32 s97, 0
    s_mov_b32 s3, 0
    s_cmp_lg_u32 s10, 8
    s_cbranch_scc1 Lq_start
    s_setprio 3
Lq_start:
    s_load_dwordx2 s[24:25], s[0:1], 8
    s_mov_b32 s26, 0x258000
    s_mov_b32 s27, 0x20000
    s_and_b32 s11, s2, 7
    s_lshr_b32 s12, s2, 3
    s_sub_u32 s12, s12, 8
    s_lshr_b32 s13, s11, 1
    s_and_b32 s15, s12, 3
    s_lshl2_add_u32 s13, s13, s15
    s_and_b32 s14, s11, 1
    s_mul_i32 s14, s14, 6
    s_lshr_b32 s16, s12, 2
    s_add_u32 s14, s14, s16
    s_mov_b32 s40, 36864
    s_mov_b32 s44, 0x1ec0800
    s_cmp_lt_u32 s2, 64
    s_cbranch_scc1 Lqkv_side
    s_cmp_lt_u32 s10, 4
    s_cbranch_scc1 Lqkv_comp
    s_cmp_eq_u32 s10, 8
    s_cbranch_scc1 Lqkv_w8
    s_add_u32 s15, s15, s16
    s_and_b32 s15, s15, 1
    s_mul_i32 s15, s15, 5
    s_sub_u32 s16, s10, 4
    v_lshrrev_b32 v12, 3, v0
    v_lshrrev_b32 v13, 4, v0
    v_and_b32 v14, 7, v0
    v_xor_b32 v14, v14, v13
    s_lshl_b32 s17, s16, 5
    v_add_u32 v12, s17, v12
    v_lshrrev_b32 v15, 1, v14
    v_lshlrev_b32 v15, 16, v15
    v_lshl_add_u32 v15, v12, 5, v15
    v_and_b32 v48, 1, v14
    v_lshl_add_u32 v15, v48, 4, v15
    v_add_u32 v48, 4096, v15
    v_xor_b32 v49, 0x20000, v48
    v_subrev_u32 v49, 768, v49
    v_subrev_u32 v50, 1536, v48
    v_subrev_u32 v51, 1536, v49
    v_mul_u32_u24 v12, 1280, v12
    v_lshl_add_u32 v2, v14, 4, v12
    v_xor_b32 v14, 4, v14
    v_lshl_add_u32 v3, v14, 4, v12
    v_add_u32 v3, 9216, v3
    v_add_u32 v4, 18432, v2
    v_add_u32 v5, 18432, v3
    s_mul_i32 s17, s16, 61440
    s_mul_i32 s18, s14, 320
    s_add_u32 s41, s17, s18
    s_mov_b32 s42, 245760
    v_add_u32 v12, 0, v0
    v_mul_u32_u24 v13, 3277, v12
    v_lshrrev_b32 v13, 16, v13
    v_mul_u32_u24 v14, 20, v13
    v_sub_u32 v12, v12, v14
    v_lshrrev_b32 v14, 2, v13
    v_and_b32 v14, 2, v14
    v_xor_b32 v12, v12, v14
    v_mul_u32_u24 v13, 3840, v13
    v_lshl_add_u32 v6, v12, 4, v13
    v_add_u32 v12, 64, v0
    v_mul_u32_u24 v13, 3277, v12
    v_lshrrev_b32 v13, 16, v13
    v_mul_u32_u24 v14, 20, v13
    v_sub_u32 v12, v12, v14
    v_lshrrev_b32 v14, 2, v13
    v_and_b32 v14, 2, v14
    v_xor_b32 v12, v12, v14
    v_mul_u32_u24 v13, 3840, v13
    v_lshl_add_u32 v7, v12, 4, v13
    v_subrev_u32 v7, 1024, v7
    v_add_u32 v12, 128, v0
    v_mul_u32_u24 v13, 3277, v12
    v_lshrrev_b32 v13, 16, v13
    v_mul_u32_u24 v14, 20, v13
    v_sub_u32 v12, v12, v14
    v_lshrrev_b32 v14, 2, v13
    v_and_b32 v14, 2, v14
    v_xor_b32 v12, v12, v14
    v_mul_u32_u24 v13, 3840, v13
    v_lshl_add_u32 v8, v12, 4, v13
    v_subrev_u32 v8, 2048, v8
    v_add_u32 v12, 192, v0
    v_mul_u32_u24 v13, 3277, v12
    v_lshrrev_b32 v13, 16, v13
    v_mul_u32_u24 v14, 20, v13
    v_sub_u32 v12, v12, v14
    v_lshrrev_b32 v14, 2, v13
    v_and_b32 v14, 2, v14
    v_xor_b32 v12, v12, v14
    v_mul_u32_u24 v13, 3840, v13
    v_lshl_add_u32 v9, v12, 4, v13
    v_subrev_u32 v9, 3072, v9
    v_add_u32 v12, 256, v0
    v_mul_u32_u24 v13, 3277, v12
    v_lshrrev_b32 v13, 16, v13
    v_mul_u32_u24 v14, 20, v13
    v_sub_u32 v12, v12, v14
    v_lshrrev_b32 v14, 2, v13
    v_and_b32 v14, 2, v14
    v_xor_b32 v12, v12, v14
    v_mul_u32_u24 v13, 3840, v13
    v_lshl_add_u32 v10, v12, 4, v13
    s_mul_i32 s18, s13, 163840
    s_add_u32 s18, s18, s3
    s_lshl_b32 s51, s13, 12
    s_add_u32 s51, s51, 0x11ff000
    s_cmp_eq_u32 s3, 0
    s_cselect_b32 s52, 10, 8
    s_mul_i32 s37, s15, s42
    s_add_u32 s37, s37, s41
    s_lshl_b32 s17, s16, 12
    s_mov_b32 s38, s17
    s_lshl_b32 s39, s16, 10
    s_add_u32 s39, s39, 0x4000
    s_waitcnt lgkmcnt(0)
    s_mov_b32 s49, s15
    s_add_u32 s50, s38, 36864
    s_add_u32 m0, s38, s39
    s_nop 0
    buffer_load_dwordx4 v6, s[24:27], s37 offen offset:0 lds
    buffer_load_dwordx4 v7, s[24:27], s37 offen offset:1024 lds
    buffer_load_dwordx4 v8, s[24:27], s37 offen offset:2048 lds
    buffer_load_dwordx4 v9, s[24:27], s37 offen offset:3072 lds
    s_add_u32 m0, m0, 4096
    s_nop 0
    buffer_load_dwordx4 v10, s[24:27], s37 offen lds
    s_cmp_eq_u32 s3, 0
    s_cbranch_scc1 Lqkv_p1
    s_add_u32 s37, s37, s42
    s_add_u32 s15, s15, 1
    s_cmp_eq_u32 s15, 10
    s_cselect_b32 s15, 0, s15
    s_cselect_b32 s37, s41, s37
    s_add_u32 m0, s50, s39
    s_nop 0
    buffer_load_dwordx4 v6, s[24:27], s37 offen offset:0 lds
    buffer_load_dwordx4 v7, s[24:27], s37 offen offset:1024 lds
    buffer_load_dwordx4 v8, s[24:27], s37 offen offset:2048 lds
    buffer_load_dwordx4 v9, s[24:27], s37 offen offset:3072 lds
    s_add_u32 m0, m0, 4096
    s_nop 0
    buffer_load_dwordx4 v10, s[24:27], s37 offen lds
    s_lshr_b32 s53, s16, 1
    s_lshl1_add_u32 s53, s13, s53
    s_lshl_b32 s53, s53, 3
    v_add_lshl_u32 v12, v0, s53, 7
    s_mov_b64 exec, 0xff
    s_lshl_b32 s11, s97, 15
    s_add_u32 s11, s11, 0x1e18800
    s_mov_b32 s12, 0
    s_mov_b64 s[88:89], exec
Lfw1:
    s_add_u32 s12, s12, 1
    s_and_b32 s99, s12, 7
    s_cbranch_scc1 Lfw1a
    s_mov_b64 exec, s[88:89]
    buffer_load_dword v20, v12, s[28:31], s11 offen sc0 sc1
    s_branch Lfw1b
Lfw1a:
    s_mov_b64 exec, s[88:89]
    buffer_load_dword v20, v12, s[28:31], s11 offen sc1
Lfw1b:
    s_waitcnt vmcnt(0)
    s_mov_b64 exec, s[88:89]
    v_cmp_ne_u32 s[88:89], s98, v20
    s_nop 0
    s_mov_b64 vcc, s[88:89]
    s_cbranch_vccz Lfw1c
    s_sleep 1
    s_cmp_lt_u32 s12, 0x40000
    s_cbranch_scc1 Lfw1
Lfw1c:
    s_mov_b64 exec, -1
    s_mov_b32 m0, s38
    s_cmp_ge_u32 s49, s52
    s_cbranch_scc1 Lda2t
    s_lshl_b32 s36, s49, 7
    s_add_u32 s36, s36, s18
    buffer_load_dwordx4 v2, s[20:23], s36 offen offset:0 sc1 lds
    buffer_load_dwordx4 v3, s[20:23], s36 offen offset:1024 sc1 lds
    buffer_load_dwordx4 v4, s[20:23], s36 offen offset:2048 sc1 lds
    buffer_load_dwordx4 v5, s[20:23], s36 offen offset:3072 sc1 lds
    s_branch Lda2e
Lda2t:
    s_lshl_b32 s36, s49, 18
    s_add_u32 s36, s36, s51
    buffer_load_dwordx4 v48, s[20:23], s36 offen offset:0 sc1 lds
    buffer_load_dwordx4 v49, s[20:23], s36 offen offset:1024 sc1 lds
    buffer_load_dwordx4 v50, s[20:23], s36 offen offset:2048 sc1 lds
    buffer_load_dwordx4 v51, s[20:23], s36 offen offset:3072 sc1 lds
Lda2e:
    s_mov_b32 m0, s50
    s_cmp_ge_u32 s15, s52
    s_cbranch_scc1 Lda3t
    s_lshl_b32 s36, s15, 7
    s_add_u32 s36, s36, s18
    buffer_load_dwordx4 v2, s[20:23], s36 offen offset:0 sc1 lds
    buffer_load_dwordx4 v3, s[20:23], s36 offen offset:1024 sc1 lds
    buffer_load_dwordx4 v4, s[20:23], s36 offen offset:2048 sc1 lds
    buffer_load_dwordx4 v5, s[20:23], s36 offen offset:3072 sc1 lds
    s_branch Lda3e
Lda3t:
    s_lshl_b32 s36, s15, 18
    s_add_u32 s36, s36, s51
    buffer_load_dwordx4 v48, s[20:23], s36 offen offset:0 sc1 lds
    buffer_load_dwordx4 v49, s[20:23], s36 offen offset:1024 sc1 lds
    buffer_load_dwordx4 v50, s[20:23], s36 offen offset:2048 sc1 lds
    buffer_load_dwordx4 v51, s[20:23], s36 offen offset:3072 sc1 lds
Lda3e:
    s_waitcnt vmcnt(4)
    s_branch Lqkv_p2
Lqkv_p1:
    s_mov_b32 m0, s38
    s_cmp_ge_u32 s15, s52
    s_cbranch_scc1 Lda4t
    s_lshl_b32 s36, s15, 7
    s_add_u32 s36, s36, s18
    buffer_load_dwordx4 v2, s[20:23], s36 offen offset:0 sc1 lds
    buffer_load_dwordx4 v3, s[20:23], s36 offen offset:1024 sc1 lds
    buffer_load_dwordx4 v4, s[20:23], s36 offen offset:2048 sc1 lds
    buffer_load_dwordx4 v5, s[20:23], s36 offen offset:3072 sc1 lds
    s_branch Lda4e
Lda4t:
    s_lshl_b32 s36, s15, 18
    s_add_u32 s36, s36, s51
    buffer_load_dwordx4 v48, s[20:23], s36 offen offset:0 sc1 lds
    buffer_load_dwordx4 v49, s[20:23], s36 offen offset:1024 sc1 lds
    buffer_load_dwordx4 v50, s[20:23], s36 offen offset:2048 sc1 lds
    buffer_load_dwordx4 v51, s[20:23], s36 offen offset:3072 sc1 lds
Lda4e:
    s_add_u32 s37, s37, s42
    s_add_u32 s15, s15, 1
    s_cmp_eq_u32 s15, 10
    s_cselect_b32 s15, 0, s15
    s_cselect_b32 s37, s41, s37
    s_mov_b32 m0, s50
    s_cmp_ge_u32 s15, s52
    s_cbranch_scc1 Lda5t
    s_lshl_b32 s36, s15, 7
    s_add_u32 s36, s36, s18
    buffer_load_dwordx4 v2, s[20:23], s36 offen offset:0 sc1 lds
    buffer_load_dwordx4 v3, s[20:23], s36 offen offset:1024 sc1 lds
    buffer_load_dwordx4 v4, s[20:23], s36 offen offset:2048 sc1 lds
    buffer_load_dwordx4 v5, s[20:23], s36 offen offset:3072 sc1 lds
    s_branch Lda5e
Lda5t:
    s_lshl_b32 s36, s15, 18
    s_add_u32 s36, s36, s51
    buffer_load_dwordx4 v48, s[20:23], s36 offen offset:0 sc1 lds
    buffer_load_dwordx4 v49, s[20:23], s36 offen offset:1024 sc1 lds
    buffer_load_dwordx4 v50, s[20:23], s36 offen offset:2048 sc1 lds
    buffer_load_dwordx4 v51, s[20:23], s36 offen offset:3072 sc1 lds
Lda5e:
    s_add_u32 m0, s50, s39
    s_nop 0
    buffer_load_dwordx4 v6, s[24:27], s37 offen offset:0 lds
    buffer_load_dwordx4 v7, s[24:27], s37 offen offset:1024 lds
    buffer_load_dwordx4 v8, s[24:27], s37 offen offset:2048 lds
    buffer_load_dwordx4 v9, s[24:27], s37 offen offset:3072 lds
    s_add_u32 m0, m0, 4096
    s_nop 0
    buffer_load_dwordx4 v10, s[24:27], s37 offen lds
    s_cmp_lg_u32 s97, 0
    s_cbranch_scc1 Lep6
    s_load_dword s98, s[28:29], s44
    s_waitcnt lgkmcnt(0)
    s_add_u32 s98, s98, 0x9e3779b9
Lep6:
Lqkv_p2:
    s_add_u32 s37, s37, s42
    s_add_u32 s15, s15, 1
    s_cmp_eq_u32 s15, 10
    s_cselect_b32 s15, 0, s15
    s_cselect_b32 s37, s41, s37
    s_add_u32 s38, s38, 73728
    s_mov_b32 s33, 0
Lqkv_lloop:
    s_waitcnt vmcnt(9)
    s_barrier
    s_mov_b32 m0, s38
    s_cmp_ge_u32 s15, s52
    s_cbranch_scc1 Lda7t
    s_lshl_b32 s36, s15, 7
    s_add_u32 s36, s36, s18
    buffer_load_dwordx4 v2, s[20:23], s36 offen offset:0 sc1 lds
    buffer_load_dwordx4 v3, s[20:23], s36 offen offset:1024 sc1 lds
    buffer_load_dwordx4 v4, s[20:23], s36 offen offset:2048 sc1 lds
    buffer_load_dwordx4 v5, s[20:23], s36 offen offset:3072 sc1 lds
    s_branch Lda7e
Lda7t:
    s_lshl_b32 s36, s15, 18
    s_add_u32 s36, s36, s51
    buffer_load_dwordx4 v48, s[20:23], s36 offen offset:0 sc1 lds
    buffer_load_dwordx4 v49, s[20:23], s36 offen offset:1024 sc1 lds
    buffer_load_dwordx4 v50, s[20:23], s36 offen offset:2048 sc1 lds
    buffer_load_dwordx4 v51, s[20:23], s36 offen offset:3072 sc1 lds
Lda7e:
    s_add_u32 m0, s38, s39
    s_nop 0
    buffer_load_dwordx4 v6, s[24:27], s37 offen offset:0 lds
    buffer_load_dwordx4 v7, s[24:27], s37 offen offset:1024 lds
    buffer_load_dwordx4 v8, s[24:27], s37 offen offset:2048 lds
    buffer_load_dwordx4 v9, s[24:27], s37 offen offset:3072 lds
    s_add_u32 m0, m0, 4096
    s_nop 0
    buffer_load_dwordx4 v10, s[24:27], s37 offen lds
    s_add_u32 s37, s37, s42
    s_add_u32 s15, s15, 1
    s_cmp_eq_u32 s15, 10
    s_cselect_b32 s15, 0, s15
    s_cselect_b32 s37, s41, s37
    s_add_u32 s38, s38, 36864
    s_cmp_ge_u32 s38, 110592
    s_cselect_b32 s38, s17, s38
    s_add_u32 s33, s33, 1
    s_cmp_lt_u32 s33, 8
    s_cbranch_scc1 Lqkv_lloop
    s_branch Lqkv_ltail
Lqkv_comp:
    s_and_b32 s16, s10, 1
    s_lshr_b32 s17, s10, 1
    v_and_b32 v160, 15, v0
    v_lshrrev_b32 v161, 4, v0
    v_bfe_u32 v162, v0, 1, 3
    v_xor_b32 v162, v162, v161
    v_lshlrev_b32 v162, 4, v162
    v_lshl_add_u32 v162, v160, 7, v162
    s_lshl_b32 s18, s17, 13
    v_add_u32 v2, s18, v162
    v_xor_b32 v3, 64, v2
    v_bfe_u32 v162, v0, 2, 2
    v_lshl_add_u32 v162, v161, 3, v162
    v_mul_u32_u24 v162, 320, v162
    v_and_b32 v163, 3, v0
    v_lshl_add_u32 v162, v163, 3, v162
    s_mul_i32 s18, s16, 160
    s_add_u32 s18, s18, 0x4000
    v_add_u32 v162, s18, v162
    v_and_b32 v163, 16, v0
    v_lshlrev_b32 v163, 1, v163
    v_add_u32 v4, v162, v163
    v_sub_u32 v5, v162, v163
    s_cmp_eq_u32 s16, 0
    s_cbranch_scc1 Lqkv_nosw
    v_swap_b32 v4, v5
Lqkv_nosw:
    v_mov_b64 v[8:9], 0
    v_mov_b64 v[10:11], 0
    v_mov_b64 v[12:13], 0
    v_mov_b64 v[14:15], 0
    v_mov_b64 v[16:17], 0
    v_mov_b64 v[18:19], 0
    v_mov_b64 v[20:21], 0
    v_mov_b64 v[22:23], 0
    v_mov_b64 v[24:25], 0
    v_mov_b64 v[26:27], 0
    v_mov_b64 v[28:29], 0
    v_mov_b64 v[30:31], 0
    v_mov_b64 v[32:33], 0
    v_mov_b64 v[34:35], 0
    v_mov_b64 v[36:37], 0
    v_mov_b64 v[38:39], 0
    v_mov_b64 v[40:41], 0
    v_mov_b64 v[42:43], 0
    v_mov_b64 v[44:45], 0
    v_mov_b64 v[46:47], 0
    v_mov_b64 v[48:49], 0
    v_mov_b64 v[50:51], 0
    v_mov_b64 v[52:53], 0
    v_mov_b64 v[54:55], 0
    v_mov_b64 v[56:57], 0
    v_mov_b64 v[58:59], 0
    v_mov_b64 v[60:61], 0
    v_mov_b64 v[62:63], 0
    v_mov_b64 v[64:65], 0
    v_mov_b64 v[66:67], 0
    v_mov_b64 v[68:69], 0
    v_mov_b64 v[70:71], 0
    v_mov_b64 v[72:73], 0
    v_mov_b64 v[74:75], 0
    v_mov_b64 v[76:77], 0
    v_mov_b64 v[78:79], 0
    v_mov_b64 v[80:81], 0
    v_mov_b64 v[82:83], 0
    v_mov_b64 v[84:85], 0
    v_mov_b64 v[86:87], 0
    s_lshl1_add_u32 s19, s14, s16
    s_mul_i32 s19, s19, 327680
    s_lshl1_add_u32 s41, s13, s17
    s_lshl_b32 s41, s41, 10
    s_add_u32 s41, s41, s19
    s_cmp_eq_u32 s3, 0
    s_cbranch_scc1 Lqkv_c1
    s_add_u32 s41, s41, 7864320
Lqkv_c1:
    s_mov_b32 s33, 0
    s_mov_b32 s34, 0
    s_waitcnt lgkmcnt(0)
    s_barrier
    ds_read_b64_tr_b16 v[104:105], v4 offset:0
    ds_read_b64_tr_b16 v[106:107], v4 offset:1280
    ds_read_b128 v[88:91], v2 offset:0
    ds_read_b128 v[92:95], v2 offset:2048
    ds_read_b128 v[96:99], v2 offset:4096
    ds_read_b128 v[100:103], v2 offset:6144
    ds_read_b64_tr_b16 v[108:109], v5 offset:32
    ds_read_b64_tr_b16 v[110:111], v5 offset:1312
    ds_read_b64_tr_b16 v[112:113], v4 offset:64
    ds_read_b64_tr_b16 v[114:115], v4 offset:1344
    ds_read_b64_tr_b16 v[116:117], v5 offset:96
    ds_read_b64_tr_b16 v[118:119], v5 offset:1376
    ds_read_b64_tr_b16 v[120:121], v4 offset:128
    ds_read_b64_tr_b16 v[122:123], v4 offset:1408
Lqkv_cloop:
    s_waitcnt lgkmcnt(11)
    v_mfma_f32_16x16x32_bf16 v[8:11], v[104:107], v[88:91], v[8:11]
    s_add_u32 s34, s34, 1
    ds_read_b64_tr_b16 v[140:141], v4 offset:10240
    s_waitcnt lgkmcnt(11)
    v_mfma_f32_16x16x32_bf16 v[12:15], v[104:107], v[92:95], v[12:15]
    s_cmp_eq_u32 s34, 3
    ds_read_b64_tr_b16 v[142:143], v4 offset:11520
    s_waitcnt lgkmcnt(11)
    v_mfma_f32_16x16x32_bf16 v[16:19], v[104:107], v[96:99], v[16:19]
    s_cselect_b32 s35, 0xfffee000, s40
    ds_read_b128 v[124:127], v3 offset:0
    s_waitcnt lgkmcnt(11)
    v_mfma_f32_16x16x32_bf16 v[20:23], v[104:107], v[100:103], v[20:23]
    s_cselect_b32 s34, 0, s34
    ds_read_b128 v[128:131], v3 offset:2048
    s_waitcnt lgkmcnt(10)
    v_mfma_f32_16x16x32_bf16 v[24:27], v[108:111], v[88:91], v[24:27]
    s_add_u32 s33, s33, 1
    ds_read_b128 v[132:135], v3 offset:4096
    v_mfma_f32_16x16x32_bf16 v[28:31], v[108:111], v[92:95], v[28:31]
    s_cmp_eq_u32 s33, 10
    ds_read_b128 v[136:139], v3 offset:6144
    v_mfma_f32_16x16x32_bf16 v[32:35], v[108:111], v[96:99], v[32:35]
    ds_read_b64_tr_b16 v[144:145], v5 offset:10272
    v_mfma_f32_16x16x32_bf16 v[36:39], v[108:111], v[100:103], v[36:39]
    ds_read_b64_tr_b16 v[146:147], v5 offset:11552
    s_waitcnt lgkmcnt(12)
    v_mfma_f32_16x16x32_bf16 v[40:43], v[112:115], v[88:91], v[40:43]
    ds_read_b64_tr_b16 v[148:149], v4 offset:10304
    v_mfma_f32_16x16x32_bf16 v[44:47], v[112:115], v[92:95], v[44:47]
    ds_read_b64_tr_b16 v[150:151], v4 offset:11584
    v_mfma_f32_16x16x32_bf16 v[48:51], v[112:115], v[96:99], v[48:51]
    ds_read_b64_tr_b16 v[152:153], v5 offset:10336
    v_mfma_f32_16x16x32_bf16 v[52:55], v[112:115], v[100:103], v[52:55]
    ds_read_b64_tr_b16 v[154:155], v5 offset:11616
    s_waitcnt lgkmcnt(14)
    v_mfma_f32_16x16x32_bf16 v[56:59], v[116:119], v[88:91], v[56:59]
    ds_read_b64_tr_b16 v[156:157], v4 offset:10368
    v_mfma_f32_16x16x32_bf16 v[60:63], v[116:119], v[92:95], v[60:63]
    ds_read_b64_tr_b16 v[158:159], v4 offset:11648
    v_mfma_f32_16x16x32_bf16 v[64:67], v[116:119], v[96:99], v[64:67]
    v_add_u32 v2, s35, v2
    v_mfma_f32_16x16x32_bf16 v[68:71], v[116:119], v[100:103], v[68:71]
    v_add_u32 v3, s35, v3
    s_waitcnt lgkmcnt(14)
    v_mfma_f32_16x16x32_bf16 v[72:75], v[120:123], v[88:91], v[72:75]
    v_add_u32 v4, s35, v4
    v_mfma_f32_16x16x32_bf16 v[76:79], v[120:123], v[92:95], v[76:79]
    v_add_u32 v5, s35, v5
    v_mfma_f32_16x16x32_bf16 v[80:83], v[120:123], v[96:99], v[80:83]
    v_mfma_f32_16x16x32_bf16 v[84:87], v[120:123], v[100:103], v[84:87]
    s_cbranch_scc1 Lqkv_cdone
    s_waitcnt lgkmcnt(0)
    v_mfma_f32_16x16x32_bf16 v[8:11], v[140:143], v[124:127], v[8:11]
    v_mfma_f32_16x16x32_bf16 v[12:15], v[140:143], v[128:131], v[12:15]
    s_barrier
    v_mfma_f32_16x16x32_bf16 v[16:19], v[140:143], v[132:135], v[16:19]
    ds_read_b64_tr_b16 v[104:105], v4 offset:0
    v_mfma_f32_16x16x32_bf16 v[20:23], v[140:143], v[136:139], v[20:23]
    ds_read_b64_tr_b16 v[106:107], v4 offset:1280
    v_mfma_f32_16x16x32_bf16 v[24:27], v[144:147], v[124:127], v[24:27]
    ds_read_b128 v[88:91], v2 offset:0
    v_mfma_f32_16x16x32_bf16 v[28:31], v[144:147], v[128:131], v[28:31]
    ds_read_b128 v[92:95], v2 offset:2048
    v_mfma_f32_16x16x32_bf16 v[32:35], v[144:147], v[132:135], v[32:35]
    ds_read_b128 v[96:99], v2 offset:4096
    v_mfma_f32_16x16x32_bf16 v[36:39], v[144:147], v[136:139], v[36:39]
    ds_read_b128 v[100:103], v2 offset:6144
    v_mfma_f32_16x16x32_bf16 v[40:43], v[148:151], v[124:127], v[40:43]
    ds_read_b64_tr_b16 v[108:109], v5 offset:32
    v_mfma_f32_16x16x32_bf16 v[44:47], v[148:151], v[128:131], v[44:47]
    ds_read_b64_tr_b16 v[110:111], v5 offset:1312
    v_mfma_f32_16x16x32_bf16 v[48:51], v[148:151], v[132:135], v[48:51]
    ds_read_b64_tr_b16 v[112:113], v4 offset:64
    v_mfma_f32_16x16x32_bf16 v[52:55], v[148:151], v[136:139], v[52:55]
    ds_read_b64_tr_b16 v[114:115], v4 offset:1344
    v_mfma_f32_16x16x32_bf16 v[56:59], v[152:155], v[124:127], v[56:59]
    ds_read_b64_tr_b16 v[116:117], v5 offset:96
    v_mfma_f32_16x16x32_bf16 v[60:63], v[152:155], v[128:131], v[60:63]
    ds_read_b64_tr_b16 v[118:119], v5 offset:1376
    v_mfma_f32_16x16x32_bf16 v[64:67], v[152:155], v[132:135], v[64:67]
    ds_read_b64_tr_b16 v[120:121], v4 offset:128
    v_mfma_f32_16x16x32_bf16 v[68:71], v[152:155], v[136:139], v[68:71]
    ds_read_b64_tr_b16 v[122:123], v4 offset:1408
    v_mfma_f32_16x16x32_bf16 v[72:75], v[156:159], v[124:127], v[72:75]
    v_mfma_f32_16x16x32_bf16 v[76:79], v[156:159], v[128:131], v[76:79]
    v_mfma_f32_16x16x32_bf16 v[80:83], v[156:159], v[132:135], v[80:83]
    v_mfma_f32_16x16x32_bf16 v[84:87], v[156:159], v[136:139], v[84:87]
    s_branch Lqkv_cloop
Lqkv_cdone:
    s_waitcnt lgkmcnt(0)
    v_mfma_f32_16x16x32_bf16 v[8:11], v[140:143], v[124:127], v[8:11]
    v_mfma_f32_16x16x32_bf16 v[12:15], v[140:143], v[128:131], v[12:15]
    v_mfma_f32_16x16x32_bf16 v[16:19], v[140:143], v[132:135], v[16:19]
    v_mfma_f32_16x16x32_bf16 v[20:23], v[140:143], v[136:139], v[20:23]
    v_mfma_f32_16x16x32_bf16 v[24:27], v[144:147], v[124:127], v[24:27]
    v_mfma_f32_16x16x32_bf16 v[28:31], v[144:147], v[128:131], v[28:31]
    v_mfma_f32_16x16x32_bf16 v[32:35], v[144:147], v[132:135], v[32:35]
    v_mfma_f32_16x16x32_bf16 v[36:39], v[144:147], v[136:139], v[36:39]
    v_mfma_f32_16x16x32_bf16 v[40:43], v[148:151], v[124:127], v[40:43]
    v_mfma_f32_16x16x32_bf16 v[44:47], v[148:151], v[128:131], v[44:47]
    v_mfma_f32_16x16x32_bf16 v[48:51], v[148:151], v[132:135], v[48:51]
    v_mfma_f32_16x16x32_bf16 v[52:55], v[148:151], v[136:139], v[52:55]
    v_mfma_f32_16x16x32_bf16 v[56:59], v[152:155], v[124:127], v[56:59]
    v_mfma_f32_16x16x32_bf16 v[60:63], v[152:155], v[128:131], v[60:63]
    v_mfma_f32_16x16x32_bf16 v[64:67], v[152:155], v[132:135], v[64:67]
    v_mfma_f32_16x16x32_bf16 v[68:71], v[152:155], v[136:139], v[68:71]
    v_mfma_f32_16x16x32_bf16 v[72:75], v[156:159], v[124:127], v[72:75]
    v_mfma_f32_16x16x32_bf16 v[76:79], v[156:159], v[128:131], v[76:79]
    v_mfma_f32_16x16x32_bf16 v[80:83], v[156:159], v[132:135], v[80:83]
    v_mfma_f32_16x16x32_bf16 v[84:87], v[156:159], v[136:139], v[84:87]
    s_mul_i32 s18, s16, 320
    s_add_u32 s18, s18, 111616
    v_lshl_add_u32 v2, v161, 4, s18
    s_lshl_b32 s18, s17, 9
    s_add_u32 s18, s18, 110592
    v_lshl_add_u32 v4, v160, 3, s18
    v_and_b32 v1, 31, v0
    v_lshlrev_b32 v1, 4, v1
    v_lshrrev_b32 v162, 5, v0
    v_lshl_add_u32 v1, v162, 15, v1
    s_barrier
    ds_read_b64 v[108:109], v4 offset:0
    ds_read_b64 v[110:111], v4 offset:128
    ds_read_b64 v[112:113], v4 offset:256
    ds_read_b64 v[114:115], v4 offset:384
    ds_read_b128 v[88:91], v2 offset:0
    ds_read_b128 v[92:95], v2 offset:64
    ds_read_b128 v[96:99], v2 offset:128
    ds_read_b128 v[100:103], v2 offset:192
    ds_read_b128 v[104:107], v2 offset:256
    s_waitcnt lgkmcnt(4)
    v_pk_fma_f32 v[8:9], v[88:89], v[108:109], v[8:9] op_sel_hi:[1,0,1] neg_lo:[0,1,0] neg_hi:[0,1,0]
    v_pk_fma_f32 v[10:11], v[90:91], v[108:109], v[10:11] op_sel_hi:[1,0,1] neg_lo:[0,1,0] neg_hi:[0,1,0]
    v_pk_mul_f32 v[8:9], v[8:9], v[108:109] op_sel:[0,1] op_sel_hi:[1,1]
    v_pk_mul_f32 v[10:11], v[10:11], v[108:109] op_sel:[0,1] op_sel_hi:[1,1]
    v_cvt_pk_bf16_f32 v116, v8, v9
    v_cvt_pk_bf16_f32 v117, v10, v11
    v_pk_fma_f32 v[12:13], v[88:89], v[110:111], v[12:13] op_sel_hi:[1,0,1] neg_lo:[0,1,0] neg_hi:[0,1,0]
    v_pk_fma_f32 v[14:15], v[90:91], v[110:111], v[14:15] op_sel_hi:[1,0,1] neg_lo:[0,1,0] neg_hi:[0,1,0]
    v_pk_mul_f32 v[12:13], v[12:13], v[110:111] op_sel:[0,1] op_sel_hi:[1,1]
    v_pk_mul_f32 v[14:15], v[14:15], v[110:111] op_sel:[0,1] op_sel_hi:[1,1]
    v_cvt_pk_bf16_f32 v118, v12, v13
    v_cvt_pk_bf16_f32 v119, v14, v15
    s_nop 0
    v_permlane16_swap_b32 v116, v118
    v_permlane16_swap_b32 v117, v119
    buffer_store_dwordx4 v[116:119], v1, s[28:31], s41 offen offset:0 sc1
    v_pk_fma_f32 v[16:17], v[88:89], v[112:113], v[16:17] op_sel_hi:[1,0,1] neg_lo:[0,1,0] neg_hi:[0,1,0]
    v_pk_fma_f32 v[18:19], v[90:91], v[112:113], v[18:19] op_sel_hi:[1,0,1] neg_lo:[0,1,0] neg_hi:[0,1,0]
    v_pk_mul_f32 v[16:17], v[16:17], v[112:113] op_sel:[0,1] op_sel_hi:[1,1]
    v_pk_mul_f32 v[18:19], v[18:19], v[112:113] op_sel:[0,1] op_sel_hi:[1,1]
    v_cvt_pk_bf16_f32 v120, v16, v17
    v_cvt_pk_bf16_f32 v121, v18, v19
    v_pk_fma_f32 v[20:21], v[88:89], v[114:115], v[20:21] op_sel_hi:[1,0,1] neg_lo:[0,1,0] neg_hi:[0,1,0]
    v_pk_fma_f32 v[22:23], v[90:91], v[114:115], v[22:23] op_sel_hi:[1,0,1] neg_lo:[0,1,0] neg_hi:[0,1,0]
    v_pk_mul_f32 v[20:21], v[20:21], v[114:115] op_sel:[0,1] op_sel_hi:[1,1]
    v_pk_mul_f32 v[22:23], v[22:23], v[114:115] op_sel:[0,1] op_sel_hi:[1,1]
    v_cvt_pk_bf16_f32 v122, v20, v21
    v_cvt_pk_bf16_f32 v123, v22, v23
    s_nop 0
    v_permlane16_swap_b32 v120, v122
    v_permlane16_swap_b32 v121, v123
    buffer_store_dwordx4 v[120:123], v1, s[28:31], s41 offen offset:512 sc1
    s_add_u32 s41, s41, 65536
    s_waitcnt lgkmcnt(3)
    v_pk_fma_f32 v[24:25], v[92:93], v[108:109], v[24:25] op_sel_hi:[1,0,1] neg_lo:[0,1,0] neg_hi:[0,1,0]
    v_pk_fma_f32 v[26:27], v[94:95], v[108:109], v[26:27] op_sel_hi:[1,0,1] neg_lo:[0,1,0] neg_hi:[0,1,0]
    v_pk_mul_f32 v[24:25], v[24:25], v[108:109] op_sel:[0,1] op_sel_hi:[1,1]
    v_pk_mul_f32 v[26:27], v[26:27], v[108:109] op_sel:[0,1] op_sel_hi:[1,1]
    v_cvt_pk_bf16_f32 v124, v24, v25
    v_cvt_pk_bf16_f32 v125, v26, v27
    v_pk_fma_f32 v[28:29], v[92:93], v[110:111], v[28:29] op_sel_hi:[1,0,1] neg_lo:[0,1,0] neg_hi:[0,1,0]
    v_pk_fma_f32 v[30:31], v[94:95], v[110:111], v[30:31] op_sel_hi:[1,0,1] neg_lo:[0,1,0] neg_hi:[0,1,0]
    v_pk_mul_f32 v[28:29], v[28:29], v[110:111] op_sel:[0,1] op_sel_hi:[1,1]
    v_pk_mul_f32 v[30:31], v[30:31], v[110:111] op_sel:[0,1] op_sel_hi:[1,1]
    v_cvt_pk_bf16_f32 v126, v28, v29
    v_cvt_pk_bf16_f32 v127, v30, v31
    s_nop 0
    v_permlane16_swap_b32 v124, v126
    v_permlane16_swap_b32 v125, v127
    buffer_store_dwordx4 v[124:127], v1, s[28:31], s41 offen offset:0 sc1
    v_pk_fma_f32 v[32:33], v[92:93], v[112:113], v[32:33] op_sel_hi:[1,0,1] neg_lo:[0,1,0] neg_hi:[0,1,0]
    v_pk_fma_f32 v[34:35], v[94:95], v[112:113], v[34:35] op_sel_hi:[1,0,1] neg_lo:[0,1,0] neg_hi:[0,1,0]
    v_pk_mul_f32 v[32:33], v[32:33], v[112:113] op_sel:[0,1] op_sel_hi:[1,1]
    v_pk_mul_f32 v[34:35], v[34:35], v[112:113] op_sel:[0,1] op_sel_hi:[1,1]
    v_cvt_pk_bf16_f32 v128, v32, v33
    v_cvt_pk_bf16_f32 v129, v34, v35
    v_pk_fma_f32 v[36:37], v[92:93], v[114:115], v[36:37] op_sel_hi:[1,0,1] neg_lo:[0,1,0] neg_hi:[0,1,0]
    v_pk_fma_f32 v[38:39], v[94:95], v[114:115], v[38:39] op_sel_hi:[1,0,1] neg_lo:[0,1,0] neg_hi:[0,1,0]
    v_pk_mul_f32 v[36:37], v[36:37], v[114:115] op_sel:[0,1] op_sel_hi:[1,1]
    v_pk_mul_f32 v[38:39], v[38:39], v[114:115] op_sel:[0,1] op_sel_hi:[1,1]
    v_cvt_pk_bf16_f32 v130, v36, v37
    v_cvt_pk_bf16_f32 v131, v38, v39
    s_nop 0
    v_permlane16_swap_b32 v128, v130
    v_permlane16_swap_b32 v129, v131
    buffer_store_dwordx4 v[128:131], v1, s[28:31], s41 offen offset:512 sc1
    s_add_u32 s41, s41, 65536
    s_waitcnt lgkmcnt(2)
    v_pk_fma_f32 v[40:41], v[96:97], v[108:109], v[40:41] op_sel_hi:[1,0,1] neg_lo:[0,1,0] neg_hi:[0,1,0]
    v_pk_fma_f32 v[42:43], v[98:99], v[108:109], v[42:43] op_sel_hi:[1,0,1] neg_lo:[0,1,0] neg_hi:[0,1,0]
    v_pk_mul_f32 v[40:41], v[40:41], v[108:109] op_sel:[0,1] op_sel_hi:[1,1]
    v_pk_mul_f32 v[42:43], v[42:43], v[108:109] op_sel:[0,1] op_sel_hi:[1,1]
    v_cvt_pk_bf16_f32 v116, v40, v41
    v_cvt_pk_bf16_f32 v117, v42, v43
    v_pk_fma_f32 v[44:45], v[96:97], v[110:111], v[44:45] op_sel_hi:[1,0,1] neg_lo:[0,1,0] neg_hi:[0,1,0]
    v_pk_fma_f32 v[46:47], v[98:99], v[110:111], v[46:47] op_sel_hi:[1,0,1] neg_lo:[0,1,0] neg_hi:[0,1,0]
    v_pk_mul_f32 v[44:45], v[44:45], v[110:111] op_sel:[0,1] op_sel_hi:[1,1]
    v_pk_mul_f32 v[46:47], v[46:47], v[110:111] op_sel:[0,1] op_sel_hi:[1,1]
    v_cvt_pk_bf16_f32 v118, v44, v45
    v_cvt_pk_bf16_f32 v119, v46, v47
    s_nop 0
    v_permlane16_swap_b32 v116, v118
    v_permlane16_swap_b32 v117, v119
    buffer_store_dwordx4 v[116:119], v1, s[28:31], s41 offen offset:0 sc1
    v_pk_fma_f32 v[48:49], v[96:97], v[112:113], v[48:49] op_sel_hi:[1,0,1] neg_lo:[0,1,0] neg_hi:[0,1,0]
    v_pk_fma_f32 v[50:51], v[98:99], v[112:113], v[50:51] op_sel_hi:[1,0,1] neg_lo:[0,1,0] neg_hi:[0,1,0]
    v_pk_mul_f32 v[48:49], v[48:49], v[112:113] op_sel:[0,1] op_sel_hi:[1,1]
    v_pk_mul_f32 v[50:51], v[50:51], v[112:113] op_sel:[0,1] op_sel_hi:[1,1]
    v_cvt_pk_bf16_f32 v120, v48, v49
    v_cvt_pk_bf16_f32 v121, v50, v51
    v_pk_fma_f32 v[52:53], v[96:97], v[114:115], v[52:53] op_sel_hi:[1,0,1] neg_lo:[0,1,0] neg_hi:[0,1,0]
    v_pk_fma_f32 v[54:55], v[98:99], v[114:115], v[54:55] op_sel_hi:[1,0,1] neg_lo:[0,1,0] neg_hi:[0,1,0]
    v_pk_mul_f32 v[52:53], v[52:53], v[114:115] op_sel:[0,1] op_sel_hi:[1,1]
    v_pk_mul_f32 v[54:55], v[54:55], v[114:115] op_sel:[0,1] op_sel_hi:[1,1]
    v_cvt_pk_bf16_f32 v122, v52, v53
    v_cvt_pk_bf16_f32 v123, v54, v55
    s_nop 0
    v_permlane16_swap_b32 v120, v122
    v_permlane16_swap_b32 v121, v123
    buffer_store_dwordx4 v[120:123], v1, s[28:31], s41 offen offset:512 sc1
    s_add_u32 s41, s41, 65536
    s_waitcnt lgkmcnt(1)
    v_pk_fma_f32 v[56:57], v[100:101], v[108:109], v[56:57] op_sel_hi:[1,0,1] neg_lo:[0,1,0] neg_hi:[0,1,0]
    v_pk_fma_f32 v[58:59], v[102:103], v[108:109], v[58:59] op_sel_hi:[1,0,1] neg_lo:[0,1,0] neg_hi:[0,1,0]
    v_pk_mul_f32 v[56:57], v[56:57], v[108:109] op_sel:[0,1] op_sel_hi:[1,1]
    v_pk_mul_f32 v[58:59], v[58:59], v[108:109] op_sel:[0,1] op_sel_hi:[1,1]
    v_cvt_pk_bf16_f32 v124, v56, v57
    v_cvt_pk_bf16_f32 v125, v58, v59
    v_pk_fma_f32 v[60:61], v[100:101], v[110:111], v[60:61] op_sel_hi:[1,0,1] neg_lo:[0,1,0] neg_hi:[0,1,0]
    v_pk_fma_f32 v[62:63], v[102:103], v[110:111], v[62:63] op_sel_hi:[1,0,1] neg_lo:[0,1,0] neg_hi:[0,1,0]
    v_pk_mul_f32 v[60:61], v[60:61], v[110:111] op_sel:[0,1] op_sel_hi:[1,1]
    v_pk_mul_f32 v[62:63], v[62:63], v[110:111] op_sel:[0,1] op_sel_hi:[1,1]
    v_cvt_pk_bf16_f32 v126, v60, v61
    v_cvt_pk_bf16_f32 v127, v62, v63
    s_nop 0
    v_permlane16_swap_b32 v124, v126
    v_permlane16_swap_b32 v125, v127
    buffer_store_dwordx4 v[124:127], v1, s[28:31], s41 offen offset:0 sc1
    v_pk_fma_f32 v[64:65], v[100:101], v[112:113], v[64:65] op_sel_hi:[1,0,1] neg_lo:[0,1,0] neg_hi:[0,1,0]
    v_pk_fma_f32 v[66:67], v[102:103], v[112:113], v[66:67] op_sel_hi:[1,0,1] neg_lo:[0,1,0] neg_hi:[0,1,0]
    v_pk_mul_f32 v[64:65], v[64:65], v[112:113] op_sel:[0,1] op_sel_hi:[1,1]
    v_pk_mul_f32 v[66:67], v[66:67], v[112:113] op_sel:[0,1] op_sel_hi:[1,1]
    v_cvt_pk_bf16_f32 v128, v64, v65
    v_cvt_pk_bf16_f32 v129, v66, v67
    v_pk_fma_f32 v[68:69], v[100:101], v[114:115], v[68:69] op_sel_hi:[1,0,1] neg_lo:[0,1,0] neg_hi:[0,1,0]
    v_pk_fma_f32 v[70:71], v[102:103], v[114:115], v[70:71] op_sel_hi:[1,0,1] neg_lo:[0,1,0] neg_hi:[0,1,0]
    v_pk_mul_f32 v[68:69], v[68:69], v[114:115] op_sel:[0,1] op_sel_hi:[1,1]
    v_pk_mul_f32 v[70:71], v[70:71], v[114:115] op_sel:[0,1] op_sel_hi:[1,1]
    v_cvt_pk_bf16_f32 v130, v68, v69
    v_cvt_pk_bf16_f32 v131, v70, v71
    s_nop 0
    v_permlane16_swap_b32 v128, v130
    v_permlane16_swap_b32 v129, v131
    buffer_store_dwordx4 v[128:131], v1, s[28:31], s41 offen offset:512 sc1
    s_add_u32 s41, s41, 65536
    s_waitcnt lgkmcnt(0)
    v_pk_fma_f32 v[72:73], v[104:105], v[108:109], v[72:73] op_sel_hi:[1,0,1] neg_lo:[0,1,0] neg_hi:[0,1,0]
    v_pk_fma_f32 v[74:75], v[106:107], v[108:109], v[74:75] op_sel_hi:[1,0,1] neg_lo:[0,1,0] neg_hi:[0,1,0]
    v_pk_mul_f32 v[72:73], v[72:73], v[108:109] op_sel:[0,1] op_sel_hi:[1,1]
    v_pk_mul_f32 v[74:75], v[74:75], v[108:109] op_sel:[0,1] op_sel_hi:[1,1]
    v_cvt_pk_bf16_f32 v116, v72, v73
    v_cvt_pk_bf16_f32 v117, v74, v75
    v_pk_fma_f32 v[76:77], v[104:105], v[110:111], v[76:77] op_sel_hi:[1,0,1] neg_lo:[0,1,0] neg_hi:[0,1,0]
    v_pk_fma_f32 v[78:79], v[106:107], v[110:111], v[78:79] op_sel_hi:[1,0,1] neg_lo:[0,1,0] neg_hi:[0,1,0]
    v_pk_mul_f32 v[76:77], v[76:77], v[110:111] op_sel:[0,1] op_sel_hi:[1,1]
    v_pk_mul_f32 v[78:79], v[78:79], v[110:111] op_sel:[0,1] op_sel_hi:[1,1]
    v_cvt_pk_bf16_f32 v118, v76, v77
    v_cvt_pk_bf16_f32 v119, v78, v79
    s_nop 0
    v_permlane16_swap_b32 v116, v118
    v_permlane16_swap_b32 v117, v119
    buffer_store_dwordx4 v[116:119], v1, s[28:31], s41 offen offset:0 sc1
    v_pk_fma_f32 v[80:81], v[104:105], v[112:113], v[80:81] op_sel_hi:[1,0,1] neg_lo:[0,1,0] neg_hi:[0,1,0]
    v_pk_fma_f32 v[82:83], v[106:107], v[112:113], v[82:83] op_sel_hi:[1,0,1] neg_lo:[0,1,0] neg_hi:[0,1,0]
    v_pk_mul_f32 v[80:81], v[80:81], v[112:113] op_sel:[0,1] op_sel_hi:[1,1]
    v_pk_mul_f32 v[82:83], v[82:83], v[112:113] op_sel:[0,1] op_sel_hi:[1,1]
    v_cvt_pk_bf16_f32 v120, v80, v81
    v_cvt_pk_bf16_f32 v121, v82, v83
    v_pk_fma_f32 v[84:85], v[104:105], v[114:115], v[84:85] op_sel_hi:[1,0,1] neg_lo:[0,1,0] neg_hi:[0,1,0]
    v_pk_fma_f32 v[86:87], v[106:107], v[114:115], v[86:87] op_sel_hi:[1,0,1] neg_lo:[0,1,0] neg_hi:[0,1,0]
    v_pk_mul_f32 v[84:85], v[84:85], v[114:115] op_sel:[0,1] op_sel_hi:[1,1]
    v_pk_mul_f32 v[86:87], v[86:87], v[114:115] op_sel:[0,1] op_sel_hi:[1,1]
    v_cvt_pk_bf16_f32 v122, v84, v85
    v_cvt_pk_bf16_f32 v123, v86, v87
    s_nop 0
    v_permlane16_swap_b32 v120, v122
    v_permlane16_swap_b32 v121, v123
    buffer_store_dwordx4 v[120:123], v1, s[28:31], s41 offen offset:512 sc1
    s_cmp_lg_u32 s97, 0
    s_cbranch_scc1 Lep8
    s_load_dword s98, s[28:29], s44
    s_waitcnt lgkmcnt(0)
    s_add_u32 s98, s98, 0x9e3779b9
Lep8:
    s_lshl1_add_u32 s18, s13, s17
    s_mul_i32 s18, s18, 24
    s_lshl1_add_u32 s19, s14, s16
    s_add_u32 s18, s18, s19
    s_lshl_b32 s18, s18, 7
    s_lshl_b32 s19, s97, 16
    s_add_u32 s18, s18, s19
    s_add_u32 s90, s18, 0x1e40800
    s_branch Lq_fin2
Lqkv_ltail:
    v_and_b32 v12, 31, v0
    v_lshlrev_b32 v2, 4, v12
    v_min_u32 v3, 19, v12
    v_lshlrev_b32 v3, 4, v3
    v_lshrrev_b32 v13, 5, v0
    v_mul_u32_u24 v13, 15360, v13
    v_add_u32 v4, v3, v13
    s_lshl2_add_u32 s19, s14, s16
    s_mul_i32 s19, s19, 320
    s_add_u32 s19, s19, 0x1e19000
    s_cmp_lt_u32 s14, 4
    s_cselect_b32 s47, 0x3ea52b5c, 1.0
    s_lshl_b32 s17, s16, 8
    s_add_u32 s17, s17, 110592
    v_lshl_add_u32 v5, v12, 3, s17
    s_mul_i32 s17, s16, 160
    s_add_u32 s17, s17, 111616
    v_lshrrev_b32 v3, 1, v3
    v_add_u32 v6, s17, v3
    s_mov_b32 s33, 0
    v_mov_b32 v44, -1
    v_mov_b32 v45, -1
    v_mov_b32 v46, -1
    v_mov_b32 v47, -1
    s_and_b32 s49, s14, 12
    s_add_u32 s49, s49, s16
    s_min_u32 s49, s49, 9
    s_and_b32 s50, s14, 3
    s_lshl3_add_u32 s53, s50, s49
    s_lshl_b32 s53, s53, 16
    s_lshl_b32 s54, s13, 11
    s_add_u32 s53, s53, s54
    s_lshl1_add_u32 s54, s50, s49
    s_lshl_b32 s54, s54, 16
    s_lshl_b32 s55, s13, 10
    s_add_u32 s54, s54, s55
    s_add_u32 s54, s54, 1572864
    s_cmp_lt_u32 s49, 8
    s_cselect_b32 s53, s53, s54
    s_movk_i32 s55, 0x4000
    s_cselect_b32 s55, 1024, s55
    s_add_u32 s53, s53, 0xf00000
    s_add_u32 s54, s53, s55
    s_add_u32 s55, s53, 32768
    s_add_u32 s56, s54, 32768
    v_lshlrev_b32 v43, 4, v0
    s_cmp_lg_u32 s3, 0
    s_cbranch_scc1 Lqkv_tail2
    s_lshl2_add_u32 s18, s13, s16
    s_lshl_b32 s18, s18, 9
    s_add_u32 s18, s18, 0x1e11000
    buffer_load_dwordx4 v[16:19], v2, s[28:31], s18 offen sc0 sc1
    buffer_load_dwordx4 v[20:23], v4, s[28:31], s19 offen sc0 sc1
    s_mov_b32 s45, s98
    s_not_b32 s46, s45
    s_waitcnt vmcnt(11)
    s_barrier
    buffer_store_dwordx4 v[44:47], v43, s[28:31], s53 offen sc1
    buffer_store_dwordx4 v[44:47], v43, s[28:31], s54 offen sc1
    buffer_store_dwordx4 v[44:47], v43, s[28:31], s55 offen sc1
    buffer_store_dwordx4 v[44:47], v43, s[28:31], s56 offen sc1
    s_waitcnt vmcnt(6)
    s_barrier
    s_waitcnt vmcnt(4)
Lqkv_hpoll:
    v_xor_b32 v18, s45, v18
    v_xor_b32 v19, s46, v19
    v_xor_b32 v21, s45, v21
    v_xor_b32 v23, s45, v23
    v_or_b32 v21, v21, v23
    v_or3_b32 v18, v18, v19, v21
    v_cmp_ne_u32 vcc, 0, v18
    s_cbranch_vccz Lqkv_hgo
    s_add_u32 s33, s33, 1
    s_cmp_gt_u32 s33, 0x40000
    s_cbranch_scc1 Lqkv_hgo
    buffer_load_dwordx4 v[16:19], v2, s[28:31], s18 offen sc0 sc1
    buffer_load_dwordx4 v[20:23], v4, s[28:31], s19 offen sc0 sc1
    s_waitcnt vmcnt(0)
    s_branch Lqkv_hpoll
Lqkv_tail2:
    s_lshl2_add_u32 s17, s13, s16
    s_lshl_b32 s17, s17, 9
    s_add_u32 s17, s17, 0x1de8000
    buffer_load_dwordx4 v[32:35], v2, s[28:31], s17 offen sc1
    buffer_load_dwordx4 v[20:23], v4, s[28:31], s19 offen sc1
    s_waitcnt vmcnt(11)
    s_barrier
    buffer_store_dwordx4 v[44:47], v43, s[28:31], s53 offen sc1
    buffer_store_dwordx4 v[44:47], v43, s[28:31], s54 offen sc1
    buffer_store_dwordx4 v[44:47], v43, s[28:31], s55 offen sc1
    buffer_store_dwordx4 v[44:47], v43, s[28:31], s56 offen sc1
    s_waitcnt vmcnt(6)
    s_barrier
    s_waitcnt vmcnt(4)
Lqkv_cnt:
    v_cmp_neq_f32 vcc, 0x41000000, v35
    s_cbranch_vccz Lqkv_cnt2
    buffer_load_dwordx4 v[32:35], v2, s[28:31], s17 offen sc0 sc1
    s_add_u32 s33, s33, 1
    s_waitcnt vmcnt(0)
    s_cmp_lt_u32 s33, 0x40000
    s_cbranch_scc1 Lqkv_cnt
Lqkv_cnt2:
    v_mul_f32 v27, 0x3acccccd, v32
    v_mul_f32 v29, 0x3acccccd, v33
    v_fma_f32 v29, -v27, v27, v29
    v_max_f32 v29, 0, v29
    v_cvt_pk_bf16_f32 v29, v29, v29
    v_and_b32 v29, 0xffff0000, v29
    v_add_f32 v29, 0x3727c5ac, v29
    v_cvt_pk_bf16_f32 v29, v29, v29
    v_and_b32 v29, 0xffff0000, v29
    v_sqrt_f32 v29, v29
    s_nop 0
    v_cvt_pk_bf16_f32 v29, v29, v29
    v_and_b32 v29, 0xffff0000, v29
    v_rcp_f32 v28, v29
    v_cvt_pk_bf16_f32 v27, v27, v27
    v_and_b32 v27, 0xffff0000, v27
    v_mul_f32 v25, 0x3acccccd, v32
    v_mul_f32 v26, 0x3acccccd, v33
    v_fma_f32 v26, -v25, v25, v26
    v_max_f32 v26, 0, v26
    v_add_f32 v29, 1.0, v28
    v_sub_f32 v30, v25, v27
    v_fma_f32 v25, v30, v28, v25
    v_mul_f32 v26, v26, v29
    v_mul_f32 v26, v26, v29
    v_cvt_pk_bf16_f32 v25, v25, v25
    v_and_b32 v25, 0xffff0000, v25
    v_cvt_pk_bf16_f32 v26, v26, v26
    v_and_b32 v26, 0xffff0000, v26
    v_add_f32 v26, 0x3727c5ac, v26
    v_cvt_pk_bf16_f32 v26, v26, v26
    v_and_b32 v26, 0xffff0000, v26
    v_sqrt_f32 v26, v26
    v_rcp_f32 v30, v29
    v_cvt_pk_bf16_f32 v26, v26, v26
    v_and_b32 v26, 0xffff0000, v26
    v_rcp_f32 v26, v26
    v_fma_f32 v16, v27, v28, v25
    v_mul_f32 v16, v16, v30
    v_mul_f32 v17, v29, v26
Lqkv_hgo:
    v_mul_f32 v17, s47, v17
    v_mov_b32 v21, v20
    v_mov_b32 v23, v22
    ds_write_b64 v5, v[16:17]
    v_permlane32_swap_b32 v20, v21
    v_permlane32_swap_b32 v22, v23
    v_add_f32 v20, v20, v21
    v_add_f32 v21, v22, v23
    ds_write_b64 v6, v[20:21]
    s_waitcnt vmcnt(0) lgkmcnt(0)
    s_barrier
    s_branch Lq_fin
Lqkv_w8:
    s_waitcnt lgkmcnt(0)
    s_cmp_lg_u32 s97, 0
    s_cbranch_scc1 Lep9
    s_load_dword s98, s[28:29], s44
    s_waitcnt lgkmcnt(0)
    s_add_u32 s98, s98, 0x9e3779b9
Lep9:
    s_cmp_lg_u32 s3, 0
    s_cbranch_scc1 Lqkv_w8b
Lqkv_w8a:
    s_load_dwordx2 s[32:33], s[0:1], 56
    s_mov_b32 s34, 0x1e0000
    s_mov_b32 s35, 0x20000
    s_load_dwordx2 s[36:37], s[0:1], 40
    s_mov_b32 s38, 0x1e0000
    s_mov_b32 s39, 0x20000
    s_load_dwordx2 s[40:41], s[0:1], 48
    s_mov_b32 s42, 0x1e0000
    s_mov_b32 s43, 0x20000
    s_sub_u32 s47, s2, 64
    s_sub_u32 s46, s47, 67
    s_min_u32 s46, s46, s47
    s_cmp_lt_u32 s46, 32
    s_cselect_b32 s46, 0, -1
    v_mov_b32 v4, s46
    v_mov_b32 v5, s46
    v_mov_b32 v6, s46
    v_mov_b32 v7, s46
    s_lshl_b32 s46, s47, 10
    s_add_u32 s46, s46, 0x1de8000
    v_lshlrev_b32 v1, 4, v0
    v_lshlrev_b32 v2, 7, v0
    s_mul_i32 s16, s47, 10240
    s_add_u32 s17, s16, 8192
    s_waitcnt lgkmcnt(0)
    s_barrier
    s_barrier
    s_barrier
    s_barrier
    s_barrier
    s_barrier
    s_barrier
    s_barrier
    s_barrier
    s_cmp_ge_u32 s47, 164
    s_cbranch_scc1 Lqkv_w8d
    buffer_store_dwordx4 v[4:7], v1, s[28:31], s46 offen sc1
Lqkv_w8d:
    s_branch Lqkv_w8c
Lqkv_w8b:
    s_barrier
    s_barrier
    s_barrier
    s_barrier
    s_barrier
    s_barrier
    s_barrier
    s_barrier
    s_barrier
Lqkv_w8c:
    s_barrier
    s_barrier
    s_branch Lq_fin
Lqkv_side:
    s_mov_b32 s13, s2
    s_mov_b32 s53, 1
    s_mov_b32 s51, 0
    s_cmp_lg_u32 s3, 0
    s_cbranch_scc1 Lfs
    v_lshrrev_b32 v5, 3, v0
    v_and_b32 v6, 7, v0
    v_lshlrev_b32 v7, 2, v0
    v_mov_b32 v8, 0
    ds_write_b32 v7, v8 offset:1024
    s_waitcnt lgkmcnt(0)
    s_barrier
    s_cmp_lg_u32 s97, 0
    s_cbranch_scc1 Lep10
    s_load_dword s98, s[28:29], s44
    s_waitcnt lgkmcnt(0)
    s_add_u32 s98, s98, 0x9e3779b9
Lep10:
    s_cmp_ge_u32 s10, 4
    s_cbranch_scc1 Lside_pack
    s_and_b32 s14, s13, 7
    s_lshr_b32 s15, s13, 3
    s_lshl3_add_u32 s14, s14, s15
    s_lshl2_add_u32 s14, s14, s10
    v_mul_u32_u24 v4, 1280, v5
    v_lshl_add_u32 v4, v6, 4, v4
    s_mul_i32 s15, s14, 10240
    buffer_load_dwordx4 v[20:23], v4, s[20:23], s15 offen offset:0
    buffer_load_dwordx4 v[24:27], v4, s[20:23], s15 offen offset:128
    buffer_load_dwordx4 v[28:31], v4, s[20:23], s15 offen offset:256
    buffer_load_dwordx4 v[32:35], v4, s[20:23], s15 offen offset:384
    buffer_load_dwordx4 v[36:39], v4, s[20:23], s15 offen offset:512
    buffer_load_dwordx4 v[40:43], v4, s[20:23], s15 offen offset:640
    buffer_load_dwordx4 v[44:47], v4, s[20:23], s15 offen offset:768
    buffer_load_dwordx4 v[48:51], v4, s[20:23], s15 offen offset:896
    buffer_load_dwordx4 v[52:55], v4, s[20:23], s15 offen offset:1024
    buffer_load_dwordx4 v[56:59], v4, s[20:23], s15 offen offset:1152
    s_cmp_ge_u32 s13, 60
    s_cselect_b32 s53, 1, 0
    s_cmp_eq_u32 s53, 1
    s_cbranch_scc1 Lside_nob
    v_mul_u32_u24 v7, 3840, v5
    v_lshl_add_u32 v7, v6, 4, v7
    s_bfe_u32 s16, s13, 0x10001
    s_mul_i32 s16, s16, 40
    s_add_u32 s16, s16, s10
    s_mul_i32 s17, s16, 30720
    s_and_b32 s18, s13, 1
    s_mul_i32 s18, s18, 15
    s_lshr_b32 s19, s13, 2
    s_add_u32 s18, s18, s19
    s_lshl_b32 s19, s18, 7
    s_add_u32 s17, s17, s19
    buffer_load_dwordx4 v[60:63], v7, s[24:27], s17 offen
    s_add_u32 s17, s17, 122880
    buffer_load_dwordx4 v[64:67], v7, s[24:27], s17 offen
    s_add_u32 s17, s17, 122880
    buffer_load_dwordx4 v[68:71], v7, s[24:27], s17 offen
    s_add_u32 s17, s17, 122880
    buffer_load_dwordx4 v[72:75], v7, s[24:27], s17 offen
    s_add_u32 s17, s17, 122880
    buffer_load_dwordx4 v[76:79], v7, s[24:27], s17 offen
    s_add_u32 s17, s17, 122880
    buffer_load_dwordx4 v[80:83], v7, s[24:27], s17 offen
    s_add_u32 s17, s17, 122880
    buffer_load_dwordx4 v[84:87], v7, s[24:27], s17 offen
    s_add_u32 s17, s17, 122880
    buffer_load_dwordx4 v[88:91], v7, s[24:27], s17 offen
    s_add_u32 s17, s17, 122880
    buffer_load_dwordx4 v[92:95], v7, s[24:27], s17 offen
    s_add_u32 s17, s17, 122880
    buffer_load_dwordx4 v[96:99], v7, s[24:27], s17 offen
    s_waitcnt vmcnt(10)
    s_branch Lside_a
Lside_nob:
    s_waitcnt vmcnt(0)
Lside_a:
    v_lshlrev_b32 v100, 16, v20
    v_and_b32 v101, 0xffff0000, v20
    v_pk_mul_f32 v[106:107], v[100:101], v[100:101]
    v_pk_add_f32 v[104:105], v[100:101], 0
    v_lshlrev_b32 v102, 16, v21
    v_and_b32 v103, 0xffff0000, v21
    v_pk_fma_f32 v[106:107], v[102:103], v[102:103], v[106:107]
    v_pk_add_f32 v[104:105], v[102:103], v[104:105]
    v_lshlrev_b32 v100, 16, v22
    v_and_b32 v101, 0xffff0000, v22
    v_pk_fma_f32 v[106:107], v[100:101], v[100:101], v[106:107]
    v_pk_add_f32 v[104:105], v[100:101], v[104:105]
    v_lshlrev_b32 v102, 16, v23
    v_and_b32 v103, 0xffff0000, v23
    v_pk_fma_f32 v[106:107], v[102:103], v[102:103], v[106:107]
    v_pk_add_f32 v[104:105], v[102:103], v[104:105]
    v_lshlrev_b32 v100, 16, v24
    v_and_b32 v101, 0xffff0000, v24
    v_pk_fma_f32 v[106:107], v[100:101], v[100:101], v[106:107]
    v_pk_add_f32 v[104:105], v[100:101], v[104:105]
    v_lshlrev_b32 v102, 16, v25
    v_and_b32 v103, 0xffff0000, v25
    v_pk_fma_f32 v[106:107], v[102:103], v[102:103], v[106:107]
    v_pk_add_f32 v[104:105], v[102:103], v[104:105]
    v_lshlrev_b32 v100, 16, v26
    v_and_b32 v101, 0xffff0000, v26
    v_pk_fma_f32 v[106:107], v[100:101], v[100:101], v[106:107]
    v_pk_add_f32 v[104:105], v[100:101], v[104:105]
    v_lshlrev_b32 v102, 16, v27
    v_and_b32 v103, 0xffff0000, v27
    v_pk_fma_f32 v[106:107], v[102:103], v[102:103], v[106:107]
    v_pk_add_f32 v[104:105], v[102:103], v[104:105]
    v_lshlrev_b32 v100, 16, v28
    v_and_b32 v101, 0xffff0000, v28
    v_pk_fma_f32 v[106:107], v[100:101], v[100:101], v[106:107]
    v_pk_add_f32 v[104:105], v[100:101], v[104:105]
    v_lshlrev_b32 v102, 16, v29
    v_and_b32 v103, 0xffff0000, v29
    v_pk_fma_f32 v[106:107], v[102:103], v[102:103], v[106:107]
    v_pk_add_f32 v[104:105], v[102:103], v[104:105]
    v_lshlrev_b32 v100, 16, v30
    v_and_b32 v101, 0xffff0000, v30
    v_pk_fma_f32 v[106:107], v[100:101], v[100:101], v[106:107]
    v_pk_add_f32 v[104:105], v[100:101], v[104:105]
    v_lshlrev_b32 v102, 16, v31
    v_and_b32 v103, 0xffff0000, v31
    v_pk_fma_f32 v[106:107], v[102:103], v[102:103], v[106:107]
    v_pk_add_f32 v[104:105], v[102:103], v[104:105]
    v_lshlrev_b32 v100, 16, v32
    v_and_b32 v101, 0xffff0000, v32
    v_pk_fma_f32 v[106:107], v[100:101], v[100:101], v[106:107]
    v_pk_add_f32 v[104:105], v[100:101], v[104:105]
    v_lshlrev_b32 v102, 16, v33
    v_and_b32 v103, 0xffff0000, v33
    v_pk_fma_f32 v[106:107], v[102:103], v[102:103], v[106:107]
    v_pk_add_f32 v[104:105], v[102:103], v[104:105]
    v_lshlrev_b32 v100, 16, v34
    v_and_b32 v101, 0xffff0000, v34
    v_pk_fma_f32 v[106:107], v[100:101], v[100:101], v[106:107]
    v_pk_add_f32 v[104:105], v[100:101], v[104:105]
    v_lshlrev_b32 v102, 16, v35
    v_and_b32 v103, 0xffff0000, v35
    v_pk_fma_f32 v[106:107], v[102:103], v[102:103], v[106:107]
    v_pk_add_f32 v[104:105], v[102:103], v[104:105]
    v_lshlrev_b32 v100, 16, v36
    v_and_b32 v101, 0xffff0000, v36
    v_pk_fma_f32 v[106:107], v[100:101], v[100:101], v[106:107]
    v_pk_add_f32 v[104:105], v[100:101], v[104:105]
    v_lshlrev_b32 v102, 16, v37
    v_and_b32 v103, 0xffff0000, v37
    v_pk_fma_f32 v[106:107], v[102:103], v[102:103], v[106:107]
    v_pk_add_f32 v[104:105], v[102:103], v[104:105]
    v_lshlrev_b32 v100, 16, v38
    v_and_b32 v101, 0xffff0000, v38
    v_pk_fma_f32 v[106:107], v[100:101], v[100:101], v[106:107]
    v_pk_add_f32 v[104:105], v[100:101], v[104:105]
    v_lshlrev_b32 v102, 16, v39
    v_and_b32 v103, 0xffff0000, v39
    v_pk_fma_f32 v[106:107], v[102:103], v[102:103], v[106:107]
    v_pk_add_f32 v[104:105], v[102:103], v[104:105]
    v_lshlrev_b32 v100, 16, v40
    v_and_b32 v101, 0xffff0000, v40
    v_pk_fma_f32 v[106:107], v[100:101], v[100:101], v[106:107]
    v_pk_add_f32 v[104:105], v[100:101], v[104:105]
    v_lshlrev_b32 v102, 16, v41
    v_and_b32 v103, 0xffff0000, v41
    v_pk_fma_f32 v[106:107], v[102:103], v[102:103], v[106:107]
    v_pk_add_f32 v[104:105], v[102:103], v[104:105]
    v_lshlrev_b32 v100, 16, v42
    v_and_b32 v101, 0xffff0000, v42
    v_pk_fma_f32 v[106:107], v[100:101], v[100:101], v[106:107]
    v_pk_add_f32 v[104:105], v[100:101], v[104:105]
    v_lshlrev_b32 v102, 16, v43
    v_and_b32 v103, 0xffff0000, v43
    v_pk_fma_f32 v[106:107], v[102:103], v[102:103], v[106:107]
    v_pk_add_f32 v[104:105], v[102:103], v[104:105]
    v_lshlrev_b32 v100, 16, v44
    v_and_b32 v101, 0xffff0000, v44
    v_pk_fma_f32 v[106:107], v[100:101], v[100:101], v[106:107]
    v_pk_add_f32 v[104:105], v[100:101], v[104:105]
    v_lshlrev_b32 v102, 16, v45
    v_and_b32 v103, 0xffff0000, v45
    v_pk_fma_f32 v[106:107], v[102:103], v[102:103], v[106:107]
    v_pk_add_f32 v[104:105], v[102:103], v[104:105]
    v_lshlrev_b32 v100, 16, v46
    v_and_b32 v101, 0xffff0000, v46
    v_pk_fma_f32 v[106:107], v[100:101], v[100:101], v[106:107]
    v_pk_add_f32 v[104:105], v[100:101], v[104:105]
    v_lshlrev_b32 v102, 16, v47
    v_and_b32 v103, 0xffff0000, v47
    v_pk_fma_f32 v[106:107], v[102:103], v[102:103], v[106:107]
    v_pk_add_f32 v[104:105], v[102:103], v[104:105]
    v_lshlrev_b32 v100, 16, v48
    v_and_b32 v101, 0xffff0000, v48
    v_pk_fma_f32 v[106:107], v[100:101], v[100:101], v[106:107]
    v_pk_add_f32 v[104:105], v[100:101], v[104:105]
    v_lshlrev_b32 v102, 16, v49
    v_and_b32 v103, 0xffff0000, v49
    v_pk_fma_f32 v[106:107], v[102:103], v[102:103], v[106:107]
    v_pk_add_f32 v[104:105], v[102:103], v[104:105]
    v_lshlrev_b32 v100, 16, v50
    v_and_b32 v101, 0xffff0000, v50
    v_pk_fma_f32 v[106:107], v[100:101], v[100:101], v[106:107]
    v_pk_add_f32 v[104:105], v[100:101], v[104:105]
    v_lshlrev_b32 v102, 16, v51
    v_and_b32 v103, 0xffff0000, v51
    v_pk_fma_f32 v[106:107], v[102:103], v[102:103], v[106:107]
    v_pk_add_f32 v[104:105], v[102:103], v[104:105]
    v_lshlrev_b32 v100, 16, v52
    v_and_b32 v101, 0xffff0000, v52
    v_pk_fma_f32 v[106:107], v[100:101], v[100:101], v[106:107]
    v_pk_add_f32 v[104:105], v[100:101], v[104:105]
    v_lshlrev_b32 v102, 16, v53
    v_and_b32 v103, 0xffff0000, v53
    v_pk_fma_f32 v[106:107], v[102:103], v[102:103], v[106:107]
    v_pk_add_f32 v[104:105], v[102:103], v[104:105]
    v_lshlrev_b32 v100, 16, v54
    v_and_b32 v101, 0xffff0000, v54
    v_pk_fma_f32 v[106:107], v[100:101], v[100:101], v[106:107]
    v_pk_add_f32 v[104:105], v[100:101], v[104:105]
    v_lshlrev_b32 v102, 16, v55
    v_and_b32 v103, 0xffff0000, v55
    v_pk_fma_f32 v[106:107], v[102:103], v[102:103], v[106:107]
    v_pk_add_f32 v[104:105], v[102:103], v[104:105]
    v_lshlrev_b32 v100, 16, v56
    v_and_b32 v101, 0xffff0000, v56
    v_pk_fma_f32 v[106:107], v[100:101], v[100:101], v[106:107]
    v_pk_add_f32 v[104:105], v[100:101], v[104:105]
    v_lshlrev_b32 v102, 16, v57
    v_and_b32 v103, 0xffff0000, v57
    v_pk_fma_f32 v[106:107], v[102:103], v[102:103], v[106:107]
    v_pk_add_f32 v[104:105], v[102:103], v[104:105]
    v_lshlrev_b32 v100, 16, v58
    v_and_b32 v101, 0xffff0000, v58
    v_pk_fma_f32 v[106:107], v[100:101], v[100:101], v[106:107]
    v_pk_add_f32 v[104:105], v[100:101], v[104:105]
    v_lshlrev_b32 v102, 16, v59
    v_and_b32 v103, 0xffff0000, v59
    v_pk_fma_f32 v[106:107], v[102:103], v[102:103], v[106:107]
    v_pk_add_f32 v[104:105], v[102:103], v[104:105]
    v_add_f32 v104, v104, v105
    v_add_f32 v106, v106, v107
    s_nop 0
    v_add_f32_dpp v104, v104, v104 quad_perm:[1,0,3,2] row_mask:0xf bank_mask:0xf
    v_add_f32_dpp v106, v106, v106 quad_perm:[1,0,3,2] row_mask:0xf bank_mask:0xf
    s_nop 0
    v_add_f32_dpp v104, v104, v104 quad_perm:[2,3,0,1] row_mask:0xf bank_mask:0xf
    v_add_f32_dpp v106, v106, v106 quad_perm:[2,3,0,1] row_mask:0xf bank_mask:0xf
    s_nop 0
    v_add_f32_dpp v104, v104, v104 row_half_mirror row_mask:0xf bank_mask:0xf
    v_add_f32_dpp v106, v106, v106 row_half_mirror row_mask:0xf bank_mask:0xf
    v_mul_f32 v108, 0x3acccccd, v104
    v_mul_f32 v100, 0x3acccccd, v106
    v_fma_f32 v100, -v108, v108, v100
    v_max_f32 v100, 0, v100
    v_cvt_pk_bf16_f32 v100, v100, v100
    v_and_b32 v100, 0xffff0000, v100
    v_add_f32 v100, 0x3727c5ac, v100
    v_cvt_pk_bf16_f32 v100, v100, v100
    v_and_b32 v100, 0xffff0000, v100
    v_sqrt_f32 v100, v100
    s_nop 0
    v_cvt_pk_bf16_f32 v100, v100, v100
    v_and_b32 v100, 0xffff0000, v100
    v_rcp_f32 v109, v100
    v_cvt_pk_bf16_f32 v108, v108, v108
    v_and_b32 v108, 0xffff0000, v108
    s_mov_b32 s54, s98
    v_mov_b32 v110, s54
    v_not_b32 v111, v110
    v_lshlrev_b32 v11, 4, v5
    s_lshl_b32 s15, s14, 7
    s_add_u32 s15, s15, 0x1e11000
    s_mov_b32 exec_lo, 0x01010101
    s_mov_b32 exec_hi, 0x01010101
    buffer_store_dwordx4 v[108:111], v11, s[28:31], s15 offen sc1
    s_mov_b64 exec, -1
    v_mov_b32 v13, 0
    v_mov_b32 v14, 1
    ds_write_b32 v13, v14 offset:1044
    s_cmp_eq_u32 s53, 1
    s_cbranch_scc1 Lside_nob2
    s_waitcnt vmcnt(1)
    v_lshlrev_b32 v100, 16, v60
    v_and_b32 v101, 0xffff0000, v60
    v_pk_add_f32 v[112:113], v[100:101], 0
    v_lshlrev_b32 v102, 16, v61
    v_and_b32 v103, 0xffff0000, v61
    v_pk_add_f32 v[114:115], v[102:103], 0
    v_lshlrev_b32 v100, 16, v62
    v_and_b32 v101, 0xffff0000, v62
    v_pk_add_f32 v[116:117], v[100:101], 0
    v_lshlrev_b32 v102, 16, v63
    v_and_b32 v103, 0xffff0000, v63
    v_pk_add_f32 v[118:119], v[102:103], 0
    v_lshlrev_b32 v100, 16, v64
    v_and_b32 v101, 0xffff0000, v64
    v_pk_add_f32 v[112:113], v[100:101], v[112:113]
    v_lshlrev_b32 v102, 16, v65
    v_and_b32 v103, 0xffff0000, v65
    v_pk_add_f32 v[114:115], v[102:103], v[114:115]
    v_lshlrev_b32 v100, 16, v66
    v_and_b32 v101, 0xffff0000, v66
    v_pk_add_f32 v[116:117], v[100:101], v[116:117]
    v_lshlrev_b32 v102, 16, v67
    v_and_b32 v103, 0xffff0000, v67
    v_pk_add_f32 v[118:119], v[102:103], v[118:119]
    v_lshlrev_b32 v100, 16, v68
    v_and_b32 v101, 0xffff0000, v68
    v_pk_add_f32 v[112:113], v[100:101], v[112:113]
    v_lshlrev_b32 v102, 16, v69
    v_and_b32 v103, 0xffff0000, v69
    v_pk_add_f32 v[114:115], v[102:103], v[114:115]
    v_lshlrev_b32 v100, 16, v70
    v_and_b32 v101, 0xffff0000, v70
    v_pk_add_f32 v[116:117], v[100:101], v[116:117]
    v_lshlrev_b32 v102, 16, v71
    v_and_b32 v103, 0xffff0000, v71
    v_pk_add_f32 v[118:119], v[102:103], v[118:119]
    v_lshlrev_b32 v100, 16, v72
    v_and_b32 v101, 0xffff0000, v72
    v_pk_add_f32 v[112:113], v[100:101], v[112:113]
    v_lshlrev_b32 v102, 16, v73
    v_and_b32 v103, 0xffff0000, v73
    v_pk_add_f32 v[114:115], v[102:103], v[114:115]
    v_lshlrev_b32 v100, 16, v74
    v_and_b32 v101, 0xffff0000, v74
    v_pk_add_f32 v[116:117], v[100:101], v[116:117]
    v_lshlrev_b32 v102, 16, v75
    v_and_b32 v103, 0xffff0000, v75
    v_pk_add_f32 v[118:119], v[102:103], v[118:119]
    v_lshlrev_b32 v100, 16, v76
    v_and_b32 v101, 0xffff0000, v76
    v_pk_add_f32 v[112:113], v[100:101], v[112:113]
    v_lshlrev_b32 v102, 16, v77
    v_and_b32 v103, 0xffff0000, v77
    v_pk_add_f32 v[114:115], v[102:103], v[114:115]
    v_lshlrev_b32 v100, 16, v78
    v_and_b32 v101, 0xffff0000, v78
    v_pk_add_f32 v[116:117], v[100:101], v[116:117]
    v_lshlrev_b32 v102, 16, v79
    v_and_b32 v103, 0xffff0000, v79
    v_pk_add_f32 v[118:119], v[102:103], v[118:119]
    v_lshlrev_b32 v100, 16, v80
    v_and_b32 v101, 0xffff0000, v80
    v_pk_add_f32 v[112:113], v[100:101], v[112:113]
    v_lshlrev_b32 v102, 16, v81
    v_and_b32 v103, 0xffff0000, v81
    v_pk_add_f32 v[114:115], v[102:103], v[114:115]
    v_lshlrev_b32 v100, 16, v82
    v_and_b32 v101, 0xffff0000, v82
    v_pk_add_f32 v[116:117], v[100:101], v[116:117]
    v_lshlrev_b32 v102, 16, v83
    v_and_b32 v103, 0xffff0000, v83
    v_pk_add_f32 v[118:119], v[102:103], v[118:119]
    v_lshlrev_b32 v100, 16, v84
    v_and_b32 v101, 0xffff0000, v84
    v_pk_add_f32 v[112:113], v[100:101], v[112:113]
    v_lshlrev_b32 v102, 16, v85
    v_and_b32 v103, 0xffff0000, v85
    v_pk_add_f32 v[114:115], v[102:103], v[114:115]
    v_lshlrev_b32 v100, 16, v86
    v_and_b32 v101, 0xffff0000, v86
    v_pk_add_f32 v[116:117], v[100:101], v[116:117]
    v_lshlrev_b32 v102, 16, v87
    v_and_b32 v103, 0xffff0000, v87
    v_pk_add_f32 v[118:119], v[102:103], v[118:119]
    v_lshlrev_b32 v100, 16, v88
    v_and_b32 v101, 0xffff0000, v88
    v_pk_add_f32 v[112:113], v[100:101], v[112:113]
    v_lshlrev_b32 v102, 16, v89
    v_and_b32 v103, 0xffff0000, v89
    v_pk_add_f32 v[114:115], v[102:103], v[114:115]
    v_lshlrev_b32 v100, 16, v90
    v_and_b32 v101, 0xffff0000, v90
    v_pk_add_f32 v[116:117], v[100:101], v[116:117]
    v_lshlrev_b32 v102, 16, v91
    v_and_b32 v103, 0xffff0000, v91
    v_pk_add_f32 v[118:119], v[102:103], v[118:119]
    v_lshlrev_b32 v100, 16, v92
    v_and_b32 v101, 0xffff0000, v92
    v_pk_add_f32 v[112:113], v[100:101], v[112:113]
    v_lshlrev_b32 v102, 16, v93
    v_and_b32 v103, 0xffff0000, v93
    v_pk_add_f32 v[114:115], v[102:103], v[114:115]
    v_lshlrev_b32 v100, 16, v94
    v_and_b32 v101, 0xffff0000, v94
    v_pk_add_f32 v[116:117], v[100:101], v[116:117]
    v_lshlrev_b32 v102, 16, v95
    v_and_b32 v103, 0xffff0000, v95
    v_pk_add_f32 v[118:119], v[102:103], v[118:119]
    v_lshlrev_b32 v100, 16, v96
    v_and_b32 v101, 0xffff0000, v96
    v_pk_add_f32 v[112:113], v[100:101], v[112:113]
    v_lshlrev_b32 v102, 16, v97
    v_and_b32 v103, 0xffff0000, v97
    v_pk_add_f32 v[114:115], v[102:103], v[114:115]
    v_lshlrev_b32 v100, 16, v98
    v_and_b32 v101, 0xffff0000, v98
    v_pk_add_f32 v[116:117], v[100:101], v[116:117]
    v_lshlrev_b32 v102, 16, v99
    v_and_b32 v103, 0xffff0000, v99
    v_pk_add_f32 v[118:119], v[102:103], v[118:119]
    v_add_f32_dpp v112, v112, v112 row_ror:8 row_mask:0xf bank_mask:0xf
    v_add_f32_dpp v113, v113, v113 row_ror:8 row_mask:0xf bank_mask:0xf
    v_add_f32_dpp v114, v114, v114 row_ror:8 row_mask:0xf bank_mask:0xf
    v_add_f32_dpp v115, v115, v115 row_ror:8 row_mask:0xf bank_mask:0xf
    v_add_f32_dpp v116, v116, v116 row_ror:8 row_mask:0xf bank_mask:0xf
    v_add_f32_dpp v117, v117, v117 row_ror:8 row_mask:0xf bank_mask:0xf
    v_add_f32_dpp v118, v118, v118 row_ror:8 row_mask:0xf bank_mask:0xf
    v_add_f32_dpp v119, v119, v119 row_ror:8 row_mask:0xf bank_mask:0xf
    v_mov_b32 v120, v112
    v_mov_b32 v121, v113
    v_mov_b32 v122, v114
    v_mov_b32 v123, v115
    v_mov_b32 v124, v116
    v_mov_b32 v125, v117
    v_mov_b32 v126, v118
    v_mov_b32 v127, v119
    v_permlane16_swap_b32 v112, v120
    v_permlane16_swap_b32 v113, v121
    v_permlane16_swap_b32 v114, v122
    v_permlane16_swap_b32 v115, v123
    v_permlane16_swap_b32 v116, v124
    v_permlane16_swap_b32 v117, v125
    v_permlane16_swap_b32 v118, v126
    v_permlane16_swap_b32 v119, v127
    v_add_f32 v112, v112, v120
    v_add_f32 v113, v113, v121
    v_add_f32 v114, v114, v122
    v_add_f32 v115, v115, v123
    v_add_f32 v116, v116, v124
    v_add_f32 v117, v117, v125
    v_add_f32 v118, v118, v126
    v_add_f32 v119, v119, v127
    v_mov_b32 v120, v112
    v_mov_b32 v121, v113
    v_mov_b32 v122, v114
    v_mov_b32 v123, v115
    v_mov_b32 v124, v116
    v_mov_b32 v125, v117
    v_mov_b32 v126, v118
    v_mov_b32 v127, v119
    v_permlane32_swap_b32 v112, v120
    v_permlane32_swap_b32 v113, v121
    v_permlane32_swap_b32 v114, v122
    v_permlane32_swap_b32 v115, v123
    v_permlane32_swap_b32 v116, v124
    v_permlane32_swap_b32 v117, v125
    v_permlane32_swap_b32 v118, v126
    v_permlane32_swap_b32 v119, v127
    v_add_f32 v112, v112, v120
    v_add_f32 v113, v113, v121
    v_add_f32 v114, v114, v122
    v_add_f32 v115, v115, v123
    v_add_f32 v116, v116, v124
    v_add_f32 v117, v117, v125
    v_add_f32 v118, v118, v126
    v_add_f32 v119, v119, v127
    s_lshl_b32 s19, s10, 8
    v_lshl_add_u32 v13, v6, 5, s19
    ds_write_b128 v13, v[112:115]
    ds_write_b128 v13, v[116:119] offset:16
Lside_nob2:
    s_lshl_b32 s19, s10, 2
    v_mov_b32 v13, s19
    s_waitcnt lgkmcnt(0)
    v_mov_b32 v14, 1
    ds_write_b32 v13, v14 offset:1024
    s_cmp_lg_u32 s10, 0
    s_cbranch_scc1 Lq_fin
Lside_meet:
    ds_read_b128 v[20:23], v13 offset:1024
    s_waitcnt lgkmcnt(0)
    v_and_b32 v20, v20, v21
    v_and_b32 v22, v22, v23
    v_and_b32 v20, v20, v22
    v_cmp_eq_u32 vcc, 0, v20
    s_cbranch_vccnz Lside_meet
    s_cmp_eq_u32 s53, 1
    s_cbranch_scc1 Lside_bump
    v_lshlrev_b32 v13, 2, v0
    ds_read_b32 v72, v13 offset:0
    ds_read_b32 v73, v13 offset:256
    ds_read_b32 v74, v13 offset:512
    ds_read_b32 v75, v13 offset:768
    s_bfe_u32 s16, s13, 0x10001
    s_mul_i32 s16, s16, 15360
    s_lshl_b32 s17, s18, 9
    s_add_u32 s16, s16, s17
    s_add_u32 s16, s16, 0x1e19000
    v_lshlrev_b32 v13, 3, v0
    s_waitcnt lgkmcnt(0)
    v_add_f32 v72, v72, v73
    v_add_f32 v72, v72, v74
    v_add_f32 v72, v72, v75
    v_mov_b32 v73, s54
    buffer_store_dwordx2 v[72:73], v13, s[28:31], s16 offen sc1
Lside_bump:
    v_mov_b32 v13, 0
    ds_write_b32 v13, v14 offset:1040
    s_branch Lq_fin
Lside_tlb:
    s_load_dwordx16 s[48:63], s[0:1], 0
    s_load_dwordx2 s[64:65], s[0:1], 64
    s_lshr_b32 s45, s13, 3
    s_lshl_b32 s45, s45, 20
    s_waitcnt lgkmcnt(0)
    s_mov_b32 s46, s45
Ltch11:
    s_min_u32 s43, s46, 32245884
    s_load_dword s47, s[28:29], s43
    s_add_u32 s46, s46, 7340032
    s_cmp_lt_u32 s46, 33294464
    s_cbranch_scc1 Ltch11
    s_mov_b32 s46, s45
Ltch12:
    s_min_u32 s43, s46, 2621436
    s_load_dword s47, s[64:65], s43
    s_add_u32 s46, s46, 7340032
    s_cmp_lt_u32 s46, 3670016
    s_cbranch_scc1 Ltch12
    s_mov_b32 s46, s45
Ltch13:
    s_min_u32 s43, s46, 1276
    s_load_dword s47, s[56:57], s43
    s_add_u32 s46, s46, 7340032
    s_cmp_lt_u32 s46, 1049856
    s_cbranch_scc1 Ltch13
    s_mov_b32 s46, s45
Ltch14:
    s_min_u32 s43, s46, 819196
    s_load_dword s47, s[52:53], s43
    s_add_u32 s46, s46, 7340032
    s_cmp_lt_u32 s46, 1867776
    s_cbranch_scc1 Ltch14
    s_mov_b32 s46, s45
Ltch15:
    s_min_u32 s43, s46, 2621436
    s_load_dword s47, s[48:49], s43
    s_add_u32 s46, s46, 7340032
    s_cmp_lt_u32 s46, 3670016
    s_cbranch_scc1 Ltch15
    s_mov_b32 s46, s45
Ltch16:
    s_min_u32 s43, s46, 2457596
    s_load_dword s47, s[50:51], s43
    s_add_u32 s46, s46, 7340032
    s_cmp_lt_u32 s46, 3506176
    s_cbranch_scc1 Ltch16
    s_branch Lq_fin
Lside_pack:
    s_mul_i32 s17, s13, 5
    s_add_u32 s17, s17, s10
    s_sub_u32 s17, s17, 284
    s_cmp_ge_u32 s13, 56
    s_cbranch_scc1 Lside_wo
    s_cmp_eq_u32 s10, 8
    s_cbranch_scc1 Lside_tlb
    s_load_dwordx2 s[36:37], s[0:1], 40
    s_mov_b32 s38, 0x1e0000
    s_mov_b32 s39, 0x20000
    s_load_dwordx2 s[40:41], s[0:1], 48
    s_mov_b32 s42, 0x1e0000
    s_mov_b32 s43, 0x20000
    s_load_dwordx2 s[48:49], s[0:1], 56
    s_mov_b32 s50, 0x1e0000
    s_mov_b32 s51, 0x20000
    s_lshl2_add_u32 s14, s13, s10
    s_sub_u32 s14, s14, 4
    s_lshr_b32 s16, s13, 3
    s_sub_u32 s17, s10, 4
    s_lshl3_add_u32 s16, s17, s16
    s_lshl_b32 s99, s16, 13
    s_cmp_ge_u32 s99, Lcode_end-Lcode_start
    s_cbranch_scc1 Lcp17x
    s_getpc_b64 s[56:57]
Lcp17:
    s_sub_u32 s56, s56, Lcp17-Lcode_start
    s_subb_u32 s57, s57, 0
    v_lshl_add_u32 v2, v0, 7, s99
    v_min_u32 v2, Lcode_end-Lcode_start, v2
    global_load_dword v36, v2, s[56:57]
Lcp17x:
    s_waitcnt lgkmcnt(0)
    s_min_u32 s77, s14, 128
    s_lshl3_add_u32 s77, s14, s77
    v_mul_u32_u24 v19, 1280, v5
    v_lshl_add_u32 v19, v6, 4, v19
    v_lshrrev_b32 v10, 2, v5
    v_lshlrev_b32 v10, 9, v10
    v_and_b32 v11, 3, v5
    v_lshl_add_u32 v10, v11, 5, v10
    v_and_b32 v11, 1, v6
    v_lshl_add_u32 v10, v11, 4, v10
    v_lshrrev_b32 v11, 1, v6
    s_mov_b32 s18, 49152
    v_mad_u32_u24 v13, v11, s18, v10
    v_mul_u32_u24 v18, 3072, v5
    v_lshl_add_u32 v18, v6, 4, v18
    s_mov_b32 s76, 40960
    v_mad_u32_u24 v14, v11, s76, v10
    v_add_u32 v15, 5120, v14
    s_cmp_ge_u32 s14, 128
    s_cbranch_scc1 Lside_ga
    s_add_u32 s52, s77, 8
    s_mul_i32 s53, s52, 6554
    s_lshr_b32 s53, s53, 16
    s_mul_i32 s18, s53, 10
    s_sub_u32 s18, s52, s18
    s_mul_i32 s19, s53, 10240
    s_lshl_b32 s55, s18, 7
    s_add_u32 s19, s19, s55
    buffer_load_dwordx4 v[136:139], v19, s[48:51], s19 offen nt
    s_mul_i32 s66, s18, 196608
    s_and_b32 s55, s53, 3
    s_lshl_b32 s55, s55, 7
    s_add_u32 s66, s66, s55
    s_lshr_b32 s55, s53, 2
    s_lshl_b32 s55, s55, 10
    s_add_u32 s66, s66, s55
    s_add_u32 s66, s66, 0x1780000
    s_add_u32 s52, s77, 8
    s_mul_i32 s53, s52, 2731
    s_lshr_b32 s53, s53, 16
    s_mul_i32 s18, s53, 24
    s_sub_u32 s18, s52, s18
    s_mul_i32 s19, s53, 24576
    s_lshl_b32 s55, s18, 7
    s_add_u32 s19, s19, s55
    buffer_load_dwordx4 v[140:143], v18, s[36:39], s19 offen nt
    buffer_load_dwordx4 v[144:147], v18, s[40:43], s19 offen nt
    s_mul_i32 s75, s18, 163840
    s_and_b32 s55, s53, 3
    s_lshl_b32 s55, s55, 7
    s_add_u32 s75, s75, s55
    s_lshr_b32 s55, s53, 2
    s_lshl_b32 s19, s55, 10
    s_add_u32 s75, s75, s19
    s_mul_i32 s55, s55, 52
    s_lshr_b32 s55, s55, 8
    s_mul_i32 s55, s55, 5120
    s_add_u32 s75, s75, s55
    s_add_u32 s75, s75, 0x1960000
Lside_ga:
    s_add_u32 s52, s77, 0
    s_mul_i32 s53, s52, 6554
    s_lshr_b32 s53, s53, 16
    s_mul_i32 s18, s53, 10
    s_sub_u32 s18, s52, s18
    s_mul_i32 s19, s53, 10240
    s_lshl_b32 s55, s18, 7
    s_add_u32 s19, s19, s55
    buffer_load_dwordx4 v[40:43], v19, s[48:51], s19 offen nt
    s_mul_i32 s58, s18, 196608
    s_and_b32 s55, s53, 3
    s_lshl_b32 s55, s55, 7
    s_add_u32 s58, s58, s55
    s_lshr_b32 s55, s53, 2
    s_lshl_b32 s55, s55, 10
    s_add_u32 s58, s58, s55
    s_add_u32 s58, s58, 0x1780000
    s_add_u32 s52, s77, 0
    s_mul_i32 s53, s52, 2731
    s_lshr_b32 s53, s53, 16
    s_mul_i32 s18, s53, 24
    s_sub_u32 s18, s52, s18
    s_mul_i32 s19, s53, 24576
    s_lshl_b32 s55, s18, 7
    s_add_u32 s19, s19, s55
    buffer_load_dwordx4 v[72:75], v18, s[36:39], s19 offen nt
    buffer_load_dwordx4 v[76:79], v18, s[40:43], s19 offen nt
    s_mul_i32 s67, s18, 163840
    s_and_b32 s55, s53, 3
    s_lshl_b32 s55, s55, 7
    s_add_u32 s67, s67, s55
    s_lshr_b32 s55, s53, 2
    s_lshl_b32 s19, s55, 10
    s_add_u32 s67, s67, s19
    s_mul_i32 s55, s55, 52
    s_lshr_b32 s55, s55, 8
    s_mul_i32 s55, s55, 5120
    s_add_u32 s67, s67, s55
    s_add_u32 s67, s67, 0x1960000
    v_mov_b32 v22, 0
Lside_hold0:
    ds_read_b32 v21, v22 offset:1044
    s_sleep 4
    s_waitcnt lgkmcnt(0)
    v_cmp_eq_u32 vcc, 0, v21
    s_cbranch_vccnz Lside_hold0
    s_add_u32 s52, s77, 1
    s_mul_i32 s53, s52, 6554
    s_lshr_b32 s53, s53, 16
    s_mul_i32 s18, s53, 10
    s_sub_u32 s18, s52, s18
    s_mul_i32 s19, s53, 10240
    s_lshl_b32 s55, s18, 7
    s_add_u32 s19, s19, s55
    buffer_load_dwordx4 v[44:47], v19, s[48:51], s19 offen nt
    s_mul_i32 s59, s18, 196608
    s_and_b32 s55, s53, 3
    s_lshl_b32 s55, s55, 7
    s_add_u32 s59, s59, s55
    s_lshr_b32 s55, s53, 2
    s_lshl_b32 s55, s55, 10
    s_add_u32 s59, s59, s55
    s_add_u32 s59, s59, 0x1780000
    s_add_u32 s52, s77, 1
    s_mul_i32 s53, s52, 2731
    s_lshr_b32 s53, s53, 16
    s_mul_i32 s18, s53, 24
    s_sub_u32 s18, s52, s18
    s_mul_i32 s19, s53, 24576
    s_lshl_b32 s55, s18, 7
    s_add_u32 s19, s19, s55
    buffer_load_dwordx4 v[80:83], v18, s[36:39], s19 offen nt
    buffer_load_dwordx4 v[84:87], v18, s[40:43], s19 offen nt
    s_mul_i32 s68, s18, 163840
    s_and_b32 s55, s53, 3
    s_lshl_b32 s55, s55, 7
    s_add_u32 s68, s68, s55
    s_lshr_b32 s55, s53, 2
    s_lshl_b32 s19, s55, 10
    s_add_u32 s68, s68, s19
    s_mul_i32 s55, s55, 52
    s_lshr_b32 s55, s55, 8
    s_mul_i32 s55, s55, 5120
    s_add_u32 s68, s68, s55
    s_add_u32 s68, s68, 0x1960000
    s_add_u32 s52, s77, 2
    s_mul_i32 s53, s52, 6554
    s_lshr_b32 s53, s53, 16
    s_mul_i32 s18, s53, 10
    s_sub_u32 s18, s52, s18
    s_mul_i32 s19, s53, 10240
    s_lshl_b32 s55, s18, 7
    s_add_u32 s19, s19, s55
    buffer_load_dwordx4 v[48:51], v19, s[48:51], s19 offen nt
    s_mul_i32 s60, s18, 196608
    s_and_b32 s55, s53, 3
    s_lshl_b32 s55, s55, 7
    s_add_u32 s60, s60, s55
    s_lshr_b32 s55, s53, 2
    s_lshl_b32 s55, s55, 10
    s_add_u32 s60, s60, s55
    s_add_u32 s60, s60, 0x1780000
    s_add_u32 s52, s77, 2
    s_mul_i32 s53, s52, 2731
    s_lshr_b32 s53, s53, 16
    s_mul_i32 s18, s53, 24
    s_sub_u32 s18, s52, s18
    s_mul_i32 s19, s53, 24576
    s_lshl_b32 s55, s18, 7
    s_add_u32 s19, s19, s55
    buffer_load_dwordx4 v[88:91], v18, s[36:39], s19 offen nt
    buffer_load_dwordx4 v[92:95], v18, s[40:43], s19 offen nt
    s_mul_i32 s69, s18, 163840
    s_and_b32 s55, s53, 3
    s_lshl_b32 s55, s55, 7
    s_add_u32 s69, s69, s55
    s_lshr_b32 s55, s53, 2
    s_lshl_b32 s19, s55, 10
    s_add_u32 s69, s69, s19
    s_mul_i32 s55, s55, 52
    s_lshr_b32 s55, s55, 8
    s_mul_i32 s55, s55, 5120
    s_add_u32 s69, s69, s55
    s_add_u32 s69, s69, 0x1960000
    s_add_u32 s52, s77, 3
    s_mul_i32 s53, s52, 6554
    s_lshr_b32 s53, s53, 16
    s_mul_i32 s18, s53, 10
    s_sub_u32 s18, s52, s18
    s_mul_i32 s19, s53, 10240
    s_lshl_b32 s55, s18, 7
    s_add_u32 s19, s19, s55
    buffer_load_dwordx4 v[52:55], v19, s[48:51], s19 offen nt
    s_mul_i32 s61, s18, 196608
    s_and_b32 s55, s53, 3
    s_lshl_b32 s55, s55, 7
    s_add_u32 s61, s61, s55
    s_lshr_b32 s55, s53, 2
    s_lshl_b32 s55, s55, 10
    s_add_u32 s61, s61, s55
    s_add_u32 s61, s61, 0x1780000
    s_add_u32 s52, s77, 3
    s_mul_i32 s53, s52, 2731
    s_lshr_b32 s53, s53, 16
    s_mul_i32 s18, s53, 24
    s_sub_u32 s18, s52, s18
    s_mul_i32 s19, s53, 24576
    s_lshl_b32 s55, s18, 7
    s_add_u32 s19, s19, s55
    buffer_load_dwordx4 v[96:99], v18, s[36:39], s19 offen nt
    buffer_load_dwordx4 v[100:103], v18, s[40:43], s19 offen nt
    s_mul_i32 s70, s18, 163840
    s_and_b32 s55, s53, 3
    s_lshl_b32 s55, s55, 7
    s_add_u32 s70, s70, s55
    s_lshr_b32 s55, s53, 2
    s_lshl_b32 s19, s55, 10
    s_add_u32 s70, s70, s19
    s_mul_i32 s55, s55, 52
    s_lshr_b32 s55, s55, 8
    s_mul_i32 s55, s55, 5120
    s_add_u32 s70, s70, s55
    s_add_u32 s70, s70, 0x1960000
    s_add_u32 s52, s77, 4
    s_mul_i32 s53, s52, 6554
    s_lshr_b32 s53, s53, 16
    s_mul_i32 s18, s53, 10
    s_sub_u32 s18, s52, s18
    s_mul_i32 s19, s53, 10240
    s_lshl_b32 s55, s18, 7
    s_add_u32 s19, s19, s55
    buffer_load_dwordx4 v[56:59], v19, s[48:51], s19 offen nt
    s_mul_i32 s62, s18, 196608
    s_and_b32 s55, s53, 3
    s_lshl_b32 s55, s55, 7
    s_add_u32 s62, s62, s55
    s_lshr_b32 s55, s53, 2
    s_lshl_b32 s55, s55, 10
    s_add_u32 s62, s62, s55
    s_add_u32 s62, s62, 0x1780000
    s_add_u32 s52, s77, 4
    s_mul_i32 s53, s52, 2731
    s_lshr_b32 s53, s53, 16
    s_mul_i32 s18, s53, 24
    s_sub_u32 s18, s52, s18
    s_mul_i32 s19, s53, 24576
    s_lshl_b32 s55, s18, 7
    s_add_u32 s19, s19, s55
    buffer_load_dwordx4 v[104:107], v18, s[36:39], s19 offen nt
    buffer_load_dwordx4 v[108:111], v18, s[40:43], s19 offen nt
    s_mul_i32 s71, s18, 163840
    s_and_b32 s55, s53, 3
    s_lshl_b32 s55, s55, 7
    s_add_u32 s71, s71, s55
    s_lshr_b32 s55, s53, 2
    s_lshl_b32 s19, s55, 10
    s_add_u32 s71, s71, s19
    s_mul_i32 s55, s55, 52
    s_lshr_b32 s55, s55, 8
    s_mul_i32 s55, s55, 5120
    s_add_u32 s71, s71, s55
    s_add_u32 s71, s71, 0x1960000
    s_add_u32 s52, s77, 5
    s_mul_i32 s53, s52, 6554
    s_lshr_b32 s53, s53, 16
    s_mul_i32 s18, s53, 10
    s_sub_u32 s18, s52, s18
    s_mul_i32 s19, s53, 10240
    s_lshl_b32 s55, s18, 7
    s_add_u32 s19, s19, s55
    buffer_load_dwordx4 v[60:63], v19, s[48:51], s19 offen nt
    s_mul_i32 s63, s18, 196608
    s_and_b32 s55, s53, 3
    s_lshl_b32 s55, s55, 7
    s_add_u32 s63, s63, s55
    s_lshr_b32 s55, s53, 2
    s_lshl_b32 s55, s55, 10
    s_add_u32 s63, s63, s55
    s_add_u32 s63, s63, 0x1780000
    s_add_u32 s52, s77, 5
    s_mul_i32 s53, s52, 2731
    s_lshr_b32 s53, s53, 16
    s_mul_i32 s18, s53, 24
    s_sub_u32 s18, s52, s18
    s_mul_i32 s19, s53, 24576
    s_lshl_b32 s55, s18, 7
    s_add_u32 s19, s19, s55
    buffer_load_dwordx4 v[112:115], v18, s[36:39], s19 offen nt
    buffer_load_dwordx4 v[116:119], v18, s[40:43], s19 offen nt
    s_mul_i32 s72, s18, 163840
    s_and_b32 s55, s53, 3
    s_lshl_b32 s55, s55, 7
    s_add_u32 s72, s72, s55
    s_lshr_b32 s55, s53, 2
    s_lshl_b32 s19, s55, 10
    s_add_u32 s72, s72, s19
    s_mul_i32 s55, s55, 52
    s_lshr_b32 s55, s55, 8
    s_mul_i32 s55, s55, 5120
    s_add_u32 s72, s72, s55
    s_add_u32 s72, s72, 0x1960000
    s_add_u32 s52, s77, 6
    s_mul_i32 s53, s52, 6554
    s_lshr_b32 s53, s53, 16
    s_mul_i32 s18, s53, 10
    s_sub_u32 s18, s52, s18
    s_mul_i32 s19, s53, 10240
    s_lshl_b32 s55, s18, 7
    s_add_u32 s19, s19, s55
    buffer_load_dwordx4 v[64:67], v19, s[48:51], s19 offen nt
    s_mul_i32 s64, s18, 196608
    s_and_b32 s55, s53, 3
    s_lshl_b32 s55, s55, 7
    s_add_u32 s64, s64, s55
    s_lshr_b32 s55, s53, 2
    s_lshl_b32 s55, s55, 10
    s_add_u32 s64, s64, s55
    s_add_u32 s64, s64, 0x1780000
    s_add_u32 s52, s77, 6
    s_mul_i32 s53, s52, 2731
    s_lshr_b32 s53, s53, 16
    s_mul_i32 s18, s53, 24
    s_sub_u32 s18, s52, s18
    s_mul_i32 s19, s53, 24576
    s_lshl_b32 s55, s18, 7
    s_add_u32 s19, s19, s55
    buffer_load_dwordx4 v[120:123], v18, s[36:39], s19 offen nt
    buffer_load_dwordx4 v[124:127], v18, s[40:43], s19 offen nt
    s_mul_i32 s73, s18, 163840
    s_and_b32 s55, s53, 3
    s_lshl_b32 s55, s55, 7
    s_add_u32 s73, s73, s55
    s_lshr_b32 s55, s53, 2
    s_lshl_b32 s19, s55, 10
    s_add_u32 s73, s73, s19
    s_mul_i32 s55, s55, 52
    s_lshr_b32 s55, s55, 8
    s_mul_i32 s55, s55, 5120
    s_add_u32 s73, s73, s55
    s_add_u32 s73, s73, 0x1960000
    s_add_u32 s52, s77, 7
    s_mul_i32 s53, s52, 6554
    s_lshr_b32 s53, s53, 16
    s_mul_i32 s18, s53, 10
    s_sub_u32 s18, s52, s18
    s_mul_i32 s19, s53, 10240
    s_lshl_b32 s55, s18, 7
    s_add_u32 s19, s19, s55
    buffer_load_dwordx4 v[68:71], v19, s[48:51], s19 offen nt
    s_mul_i32 s65, s18, 196608
    s_and_b32 s55, s53, 3
    s_lshl_b32 s55, s55, 7
    s_add_u32 s65, s65, s55
    s_lshr_b32 s55, s53, 2
    s_lshl_b32 s55, s55, 10
    s_add_u32 s65, s65, s55
    s_add_u32 s65, s65, 0x1780000
    s_add_u32 s52, s77, 7
    s_mul_i32 s53, s52, 2731
    s_lshr_b32 s53, s53, 16
    s_mul_i32 s18, s53, 24
    s_sub_u32 s18, s52, s18
    s_mul_i32 s19, s53, 24576
    s_lshl_b32 s55, s18, 7
    s_add_u32 s19, s19, s55
    buffer_load_dwordx4 v[128:131], v18, s[36:39], s19 offen nt
    buffer_load_dwordx4 v[132:135], v18, s[40:43], s19 offen nt
    s_mul_i32 s74, s18, 163840
    s_and_b32 s55, s53, 3
    s_lshl_b32 s55, s55, 7
    s_add_u32 s74, s74, s55
    s_lshr_b32 s55, s53, 2
    s_lshl_b32 s19, s55, 10
    s_add_u32 s74, s74, s19
    s_mul_i32 s55, s55, 52
    s_lshr_b32 s55, s55, 8
    s_mul_i32 s55, s55, 5120
    s_add_u32 s74, s74, s55
    s_add_u32 s74, s74, 0x1960000
    v_mov_b32 v22, 0
Lside_hold:
    ds_read_b32 v21, v22 offset:1040
    s_sleep 4
    s_waitcnt lgkmcnt(0)
    v_cmp_eq_u32 vcc, 0, v21
    s_cbranch_vccnz Lside_hold
    s_waitcnt vmcnt(21)
    buffer_store_dwordx4 v[40:43], v13, s[28:31], s58 offen sc1
    buffer_store_dwordx4 v[72:75], v14, s[28:31], s67 offen sc1
    buffer_store_dwordx4 v[76:79], v15, s[28:31], s67 offen sc1
    s_waitcnt vmcnt(21)
    buffer_store_dwordx4 v[44:47], v13, s[28:31], s59 offen sc1
    buffer_store_dwordx4 v[80:83], v14, s[28:31], s68 offen sc1
    buffer_store_dwordx4 v[84:87], v15, s[28:31], s68 offen sc1
    s_waitcnt vmcnt(21)
    buffer_store_dwordx4 v[48:51], v13, s[28:31], s60 offen sc1
    buffer_store_dwordx4 v[88:91], v14, s[28:31], s69 offen sc1
    buffer_store_dwordx4 v[92:95], v15, s[28:31], s69 offen sc1
    s_waitcnt vmcnt(21)
    buffer_store_dwordx4 v[52:55], v13, s[28:31], s61 offen sc1
    buffer_store_dwordx4 v[96:99], v14, s[28:31], s70 offen sc1
    buffer_store_dwordx4 v[100:103], v15, s[28:31], s70 offen sc1
    s_waitcnt vmcnt(21)
    buffer_store_dwordx4 v[56:59], v13, s[28:31], s62 offen sc1
    buffer_store_dwordx4 v[104:107], v14, s[28:31], s71 offen sc1
    buffer_store_dwordx4 v[108:111], v15, s[28:31], s71 offen sc1
    s_waitcnt vmcnt(21)
    buffer_store_dwordx4 v[60:63], v13, s[28:31], s63 offen sc1
    buffer_store_dwordx4 v[112:115], v14, s[28:31], s72 offen sc1
    buffer_store_dwordx4 v[116:119], v15, s[28:31], s72 offen sc1
    s_waitcnt vmcnt(21)
    buffer_store_dwordx4 v[64:67], v13, s[28:31], s64 offen sc1
    buffer_store_dwordx4 v[120:123], v14, s[28:31], s73 offen sc1
    buffer_store_dwordx4 v[124:127], v15, s[28:31], s73 offen sc1
    s_waitcnt vmcnt(21)
    buffer_store_dwordx4 v[68:71], v13, s[28:31], s65 offen sc1
    buffer_store_dwordx4 v[128:131], v14, s[28:31], s74 offen sc1
    buffer_store_dwordx4 v[132:135], v15, s[28:31], s74 offen sc1
    s_cmp_ge_u32 s14, 128
    s_cbranch_scc1 Lq_fin
    buffer_store_dwordx4 v[136:139], v13, s[28:31], s66 offen sc1
    buffer_store_dwordx4 v[140:143], v14, s[28:31], s75 offen sc1
    buffer_store_dwordx4 v[144:147], v15, s[28:31], s75 offen sc1
    s_branch Lq_fin
Lside_wo:
    s_load_dwordx2 s[32:33], s[0:1], 16
    s_mov_b32 s34, 0xc8000
    s_mov_b32 s35, 0x20000
    s_lshr_b32 s16, s17, 1
    s_and_b32 s19, s17, 1
    s_lshl_b32 s79, s17, 7
    s_add_u32 s79, s79, 0x1e58800
    s_sub_u32 s78, s10, 4
    s_mul_i32 s78, s78, 20480
    s_add_u32 s78, s78, 2048
    s_cmp_lt_u32 s16, 16
    s_cselect_b32 s52, 8, 40
    s_mul_i32 s53, s16, 40
    s_sub_u32 s54, s16, 16
    s_mul_i32 s54, s54, 160
    s_add_u32 s54, s54, 16
    s_cmp_lt_u32 s16, 16
    s_cselect_b32 s53, s53, s54
    s_cselect_b32 s54, 24, 80
    s_mul_i32 s53, s53, 1280
    s_mul_i32 s54, s54, 1280
    s_lshl_b32 s55, s19, 9
    s_lshl_b32 s56, s19, 7
    s_add_u32 s56, s56, 512
    v_add_u32 v10, 0, v0
    v_mul_u32_u24 v11, 1639, v10
    v_lshrrev_b32 v11, 16, v11
    v_mul_u32_u24 v12, 40, v11
    v_sub_u32 v10, v10, v12
    v_lshrrev_b32 v12, 2, v11
    v_and_b32 v11, 3, v11
    v_mad_u32_u24 v11, v12, s52, v11
    v_mul_u32_u24 v11, 1280, v11
    v_lshl_add_u32 v11, v10, 4, v11
    v_mov_b32 v12, s55
    v_mov_b32 v13, s56
    v_cmp_gt_u32 vcc, 32, v10
    s_nop 1
    v_cndmask_b32 v12, v13, v12, vcc
    v_add_u32 v20, v11, v12
    v_add_u32 v10, 64, v0
    v_mul_u32_u24 v11, 1639, v10
    v_lshrrev_b32 v11, 16, v11
    v_mul_u32_u24 v12, 40, v11
    v_sub_u32 v10, v10, v12
    v_lshrrev_b32 v12, 2, v11
    v_and_b32 v11, 3, v11
    v_mad_u32_u24 v11, v12, s52, v11
    v_mul_u32_u24 v11, 1280, v11
    v_lshl_add_u32 v11, v10, 4, v11
    v_mov_b32 v12, s55
    v_mov_b32 v13, s56
    v_cmp_gt_u32 vcc, 32, v10
    s_nop 1
    v_cndmask_b32 v12, v13, v12, vcc
    v_add_u32 v21, v11, v12
    v_add_u32 v10, 128, v0
    v_mul_u32_u24 v11, 1639, v10
    v_lshrrev_b32 v11, 16, v11
    v_mul_u32_u24 v12, 40, v11
    v_sub_u32 v10, v10, v12
    v_lshrrev_b32 v12, 2, v11
    v_and_b32 v11, 3, v11
    v_mad_u32_u24 v11, v12, s52, v11
    v_mul_u32_u24 v11, 1280, v11
    v_lshl_add_u32 v11, v10, 4, v11
    v_mov_b32 v12, s55
    v_mov_b32 v13, s56
    v_cmp_gt_u32 vcc, 32, v10
    s_nop 1
    v_cndmask_b32 v12, v13, v12, vcc
    v_add_u32 v22, v11, v12
    v_add_u32 v10, 192, v0
    v_mul_u32_u24 v11, 1639, v10
    v_lshrrev_b32 v11, 16, v11
    v_mul_u32_u24 v12, 40, v11
    v_sub_u32 v10, v10, v12
    v_lshrrev_b32 v12, 2, v11
    v_and_b32 v11, 3, v11
    v_mad_u32_u24 v11, v12, s52, v11
    v_mul_u32_u24 v11, 1280, v11
    v_lshl_add_u32 v11, v10, 4, v11
    v_mov_b32 v12, s55
    v_mov_b32 v13, s56
    v_cmp_gt_u32 vcc, 32, v10
    s_nop 1
    v_cndmask_b32 v12, v13, v12, vcc
    v_add_u32 v23, v11, v12
    v_add_u32 v10, 256, v0
    v_mul_u32_u24 v11, 1639, v10
    v_lshrrev_b32 v11, 16, v11
    v_mul_u32_u24 v12, 40, v11
    v_sub_u32 v10, v10, v12
    v_lshrrev_b32 v12, 2, v11
    v_and_b32 v11, 3, v11
    v_mad_u32_u24 v11, v12, s52, v11
    v_mul_u32_u24 v11, 1280, v11
    v_lshl_add_u32 v11, v10, 4, v11
    v_mov_b32 v12, s55
    v_mov_b32 v13, s56
    v_cmp_gt_u32 vcc, 32, v10
    s_nop 1
    v_cndmask_b32 v12, v13, v12, vcc
    v_add_u32 v24, v11, v12
    s_waitcnt lgkmcnt(0)
    s_add_u32 s57, s53, 0
    s_add_u32 m0, s78, 0
    s_nop 0
    buffer_load_dwordx4 v20, s[32:35], s57 offen nt lds
    s_add_u32 m0, s78, 1024
    s_nop 0
    buffer_load_dwordx4 v21, s[32:35], s57 offen nt lds
    s_add_u32 m0, s78, 2048
    s_nop 0
    buffer_load_dwordx4 v22, s[32:35], s57 offen nt lds
    s_add_u32 m0, s78, 3072
    s_nop 0
    buffer_load_dwordx4 v23, s[32:35], s57 offen nt lds
    s_add_u32 m0, s78, 4096
    s_nop 0
    buffer_load_dwordx4 v24, s[32:35], s57 offen nt lds
    v_mov_b32 v32, 0
Lside_hold3:
    ds_read_b32 v31, v32 offset:1044
    s_sleep 4
    s_waitcnt lgkmcnt(0)
    v_cmp_eq_u32 vcc, 0, v31
    s_cbranch_vccnz Lside_hold3
    s_add_u32 s57, s53, 0
    s_add_u32 s57, s57, s54
    s_add_u32 m0, s78, 5120
    s_nop 0
    buffer_load_dwordx4 v20, s[32:35], s57 offen nt lds
    s_add_u32 m0, s78, 6144
    s_nop 0
    buffer_load_dwordx4 v21, s[32:35], s57 offen nt lds
    s_add_u32 m0, s78, 7168
    s_nop 0
    buffer_load_dwordx4 v22, s[32:35], s57 offen nt lds
    s_add_u32 m0, s78, 8192
    s_nop 0
    buffer_load_dwordx4 v23, s[32:35], s57 offen nt lds
    s_add_u32 m0, s78, 9216
    s_nop 0
    buffer_load_dwordx4 v24, s[32:35], s57 offen nt lds
    s_add_u32 s57, s53, 5120
    s_add_u32 m0, s78, 10240
    s_nop 0
    buffer_load_dwordx4 v20, s[32:35], s57 offen nt lds
    s_add_u32 m0, s78, 11264
    s_nop 0
    buffer_load_dwordx4 v21, s[32:35], s57 offen nt lds
    s_add_u32 m0, s78, 12288
    s_nop 0
    buffer_load_dwordx4 v22, s[32:35], s57 offen nt lds
    s_add_u32 m0, s78, 13312
    s_nop 0
    buffer_load_dwordx4 v23, s[32:35], s57 offen nt lds
    s_add_u32 m0, s78, 14336
    s_nop 0
    buffer_load_dwordx4 v24, s[32:35], s57 offen nt lds
    s_add_u32 s57, s53, 5120
    s_add_u32 s57, s57, s54
    s_add_u32 m0, s78, 15360
    s_nop 0
    buffer_load_dwordx4 v20, s[32:35], s57 offen nt lds
    s_add_u32 m0, s78, 16384
    s_nop 0
    buffer_load_dwordx4 v21, s[32:35], s57 offen nt lds
    s_add_u32 m0, s78, 17408
    s_nop 0
    buffer_load_dwordx4 v22, s[32:35], s57 offen nt lds
    s_add_u32 m0, s78, 18432
    s_nop 0
    buffer_load_dwordx4 v23, s[32:35], s57 offen nt lds
    s_add_u32 m0, s78, 19456
    s_nop 0
    buffer_load_dwordx4 v24, s[32:35], s57 offen nt lds
    s_mul_i32 s16, s16, 5120
    s_mul_i32 s19, s19, 409600
    s_add_u32 s16, s16, s19
    s_add_u32 s16, s16, 0x1d20000
    v_lshlrev_b32 v18, 4, v0
    v_lshrrev_b32 v10, 2, v0
    v_mul_u32_u24 v10, 640, v10
    v_and_b32 v11, 3, v0
    v_lshl_add_u32 v10, v11, 3, v10
    v_add_u32 v10, s78, v10
    v_mov_b32 v22, 0
Lside_hold2:
    ds_read_b32 v21, v22 offset:1040
    s_sleep 4
    s_waitcnt lgkmcnt(0)
    v_cmp_eq_u32 vcc, 0, v21
    s_cbranch_vccnz Lside_hold2
    s_waitcnt vmcnt(0)
    ds_read_b64_tr_b16 v[40:41], v10 offset:0
    ds_read_b64_tr_b16 v[42:43], v10 offset:10240
    ds_read_b64_tr_b16 v[44:45], v10 offset:32
    ds_read_b64_tr_b16 v[46:47], v10 offset:10272
    ds_read_b64_tr_b16 v[48:49], v10 offset:64
    ds_read_b64_tr_b16 v[50:51], v10 offset:10304
    ds_read_b64_tr_b16 v[52:53], v10 offset:96
    ds_read_b64_tr_b16 v[54:55], v10 offset:10336
    ds_read_b64_tr_b16 v[56:57], v10 offset:512
    ds_read_b64_tr_b16 v[58:59], v10 offset:10752
    s_add_u32 s17, s16, 4096
    s_waitcnt lgkmcnt(0)
    buffer_store_dwordx4 v[40:43], v18, s[28:31], s16 offen offset:0 sc1
    buffer_store_dwordx4 v[44:47], v18, s[28:31], s16 offen offset:1024 sc1
    buffer_store_dwordx4 v[48:51], v18, s[28:31], s16 offen offset:2048 sc1
    buffer_store_dwordx4 v[52:55], v18, s[28:31], s16 offen offset:3072 sc1
    buffer_store_dwordx4 v[56:59], v18, s[28:31], s17 offen offset:0 sc1
    s_add_u32 s16, s16, 102400
    ds_read_b64_tr_b16 v[60:61], v10 offset:128
    ds_read_b64_tr_b16 v[62:63], v10 offset:10368
    ds_read_b64_tr_b16 v[64:65], v10 offset:160
    ds_read_b64_tr_b16 v[66:67], v10 offset:10400
    ds_read_b64_tr_b16 v[68:69], v10 offset:192
    ds_read_b64_tr_b16 v[70:71], v10 offset:10432
    ds_read_b64_tr_b16 v[72:73], v10 offset:224
    ds_read_b64_tr_b16 v[74:75], v10 offset:10464
    ds_read_b64_tr_b16 v[76:77], v10 offset:544
    ds_read_b64_tr_b16 v[78:79], v10 offset:10784
    s_add_u32 s17, s16, 4096
    s_waitcnt lgkmcnt(0)
    buffer_store_dwordx4 v[60:63], v18, s[28:31], s16 offen offset:0 sc1
    buffer_store_dwordx4 v[64:67], v18, s[28:31], s16 offen offset:1024 sc1
    buffer_store_dwordx4 v[68:71], v18, s[28:31], s16 offen offset:2048 sc1
    buffer_store_dwordx4 v[72:75], v18, s[28:31], s16 offen offset:3072 sc1
    buffer_store_dwordx4 v[76:79], v18, s[28:31], s17 offen offset:0 sc1
    s_add_u32 s16, s16, 102400
    ds_read_b64_tr_b16 v[80:81], v10 offset:256
    ds_read_b64_tr_b16 v[82:83], v10 offset:10496
    ds_read_b64_tr_b16 v[84:85], v10 offset:288
    ds_read_b64_tr_b16 v[86:87], v10 offset:10528
    ds_read_b64_tr_b16 v[88:89], v10 offset:320
    ds_read_b64_tr_b16 v[90:91], v10 offset:10560
    ds_read_b64_tr_b16 v[92:93], v10 offset:352
    ds_read_b64_tr_b16 v[94:95], v10 offset:10592
    ds_read_b64_tr_b16 v[96:97], v10 offset:576
    ds_read_b64_tr_b16 v[98:99], v10 offset:10816
    s_add_u32 s17, s16, 4096
    s_waitcnt lgkmcnt(0)
    buffer_store_dwordx4 v[80:83], v18, s[28:31], s16 offen offset:0 sc1
    buffer_store_dwordx4 v[84:87], v18, s[28:31], s16 offen offset:1024 sc1
    buffer_store_dwordx4 v[88:91], v18, s[28:31], s16 offen offset:2048 sc1
    buffer_store_dwordx4 v[92:95], v18, s[28:31], s16 offen offset:3072 sc1
    buffer_store_dwordx4 v[96:99], v18, s[28:31], s17 offen offset:0 sc1
    s_add_u32 s16, s16, 102400
    ds_read_b64_tr_b16 v[100:101], v10 offset:384
    ds_read_b64_tr_b16 v[102:103], v10 offset:10624
    ds_read_b64_tr_b16 v[104:105], v10 offset:416
    ds_read_b64_tr_b16 v[106:107], v10 offset:10656
    ds_read_b64_tr_b16 v[108:109], v10 offset:448
    ds_read_b64_tr_b16 v[110:111], v10 offset:10688
    ds_read_b64_tr_b16 v[112:113], v10 offset:480
    ds_read_b64_tr_b16 v[114:115], v10 offset:10720
    ds_read_b64_tr_b16 v[116:117], v10 offset:608
    ds_read_b64_tr_b16 v[118:119], v10 offset:10848
    s_add_u32 s17, s16, 4096
    s_waitcnt lgkmcnt(0)
    buffer_store_dwordx4 v[100:103], v18, s[28:31], s16 offen offset:0 sc1
    buffer_store_dwordx4 v[104:107], v18, s[28:31], s16 offen offset:1024 sc1
    buffer_store_dwordx4 v[108:111], v18, s[28:31], s16 offen offset:2048 sc1
    buffer_store_dwordx4 v[112:115], v18, s[28:31], s16 offen offset:3072 sc1
    buffer_store_dwordx4 v[116:119], v18, s[28:31], s17 offen offset:0 sc1
    s_add_u32 s16, s16, 102400
    s_mov_b32 s90, s79
    s_branch Lq_fin2
Lq_fin:
    s_mov_b32 s90, 0
Lq_fin2:
    s_mov_b64 exec, -1
    s_mul_i32 s91, s13, 12
    s_add_u32 s91, s91, s14
    s_add_u32 s91, s91, 64
    s_cmp_lt_u32 s2, 64
    s_cselect_b32 s91, s2, s91
    s_lshl_b32 s91, s91, 7
    s_lshl_b32 s4, s97, 15
    s_add_u32 s91, s91, s4
    s_add_u32 s91, s91, 0x1e20800
    s_add_u32 s97, s97, 1
    s_cmp_eq_u32 s3, 0
    s_cselect_b32 s63, 0, 68608
    s_cselect_b32 s4, 0, 80
    s_cselect_b32 s5, 0, 7864320
    s_mov_b32 s66, 0x4000000
    s_cselect_b32 s66, 2621440, s66
    s_load_dwordx2 s[64:65], s[0:1], s4
    s_mov_b32 s67, 0x20000
    s_mov_b32 s20, s28
    s_mov_b32 s21, s29
    s_mov_b32 s22, s30
    s_mov_b32 s23, s31
    s_load_dwordx2 s[68:69], s[0:1], 32
    s_mov_b32 s70, 0x500
    s_mov_b32 s71, 0x20000
    s_and_b32 s11, s2, 7
    s_lshr_b32 s12, s2, 3
    s_lshr_b32 s72, s11, 1
    s_and_b32 s73, s12, 7
    s_lshl3_add_u32 s72, s72, s73
    s_and_b32 s74, s11, 1
    s_lshr_b32 s75, s12, 3
    s_lshl2_add_u32 s74, s74, s75
    s_and_b32 s73, s12, 3
    s_lshl2_add_u32 s72, s11, s73
    s_lshr_b32 s74, s12, 2
    s_mov_b32 s75, s74
    s_add_u32 s73, s73, s75
    s_and_b32 s73, s73, 3
    s_and_b32 s13, s12, 3
    s_lshl2_add_u32 s13, s11, s13
    s_lshr_b32 s14, s12, 2
    s_cmp_lt_u32 s2, 30
    s_cselect_b32 s9, s3, 0
    s_min_u32 s9, s9, 1
    s_cmp_eq_u32 s10, 8
    s_cbranch_scc1 Lao_loader
    s_lshr_b32 s15, s13, 1
    s_mul_i32 s15, s15, 5
    s_and_b32 s16, s13, 1
    s_mul_i32 s17, s16, 3
    s_add_u32 s17, s17, s15
    s_lshl_b32 s17, s17, 15
    s_add_u32 s18, s15, 2
    s_lshl_b32 s18, s18, 15
    s_lshl2_add_u32 s19, s14, s10
    s_sub_u32 s24, s19, 4
    s_cmp_lt_u32 s19, 4
    s_cselect_b32 s19, s19, s24
    s_cselect_b32 s46, 1, 0
    s_mov_b32 s8, s19
    s_lshl_b32 s19, s19, 10
    s_add_u32 s19, s19, 2621440
    s_add_u32 s19, s19, s5
    s_add_u32 s24, s17, s19
    s_add_u32 s25, s18, s19
    s_lshl3_add_u32 s26, s14, s10
    s_lshl_b32 s26, s26, 9
    s_add_u32 s27, s17, s26
    s_lshl3_add_u32 s44, s16, s18
    s_add_u32 s44, s44, s26
    s_lshl_b32 s45, s10, 10
    v_lshlrev_b32 v1, 4, v0
    v_and_b32 v14, 31, v0
    v_lshrrev_b32 v15, 5, v0
    v_lshlrev_b32 v11, 4, v14
    v_lshl_add_u32 v152, v15, 15, v11
    v_mov_b32 v6, 0x3f80
    v_mov_b32 v7, 0
    s_cmp_eq_u32 s46, 1
    s_cselect_b32 s47, 0xf149, 0
    s_or_b32 s47, s47, 0x3f800000
    v_mov_b32 v48, s47
    v_mov_b32 v49, 0x3f803f80
    v_mov_b32 v50, 0x3f803f80
    v_mov_b32 v51, 0x3f803f80
    s_lshl_b32 s48, s10, 9
    v_mul_u32_u24 v12, 8256, v15
    v_add3_u32 v8, v12, v11, s48
    s_lshl3_add_u32 s51, s16, s48
    s_add_u32 s51, s51, 16512
    s_add_u32 s52, s48, 49536
    v_mov_b32 v12, s51
    v_mov_b32 v13, s52
    v_cmp_eq_u32 vcc, 0, v15
    s_nop 1
    v_cndmask_b32 v12, v13, v12, vcc
    v_add_u32 v9, v12, v11
    v_and_b32 v12, 1, v0
    v_lshlrev_b32 v12, 3, v12
    v_bfe_u32 v13, v0, 1, 1
    v_mul_u32_u24 v13, 8256, v13
    v_add3_u32 v12, v12, v13, s48
    v_add_u32 v12, 24768, v12
    s_add_u32 s51, s51, 24768
    s_add_u32 s52, s52, 8
    v_mov_b32 v13, s51
    v_mov_b32 v10, s52
    v_and_b32 v11, 3, v0
    v_cmp_eq_u32 vcc, 0, v11
    s_nop 1
    v_cndmask_b32 v13, v10, v13, vcc
    v_and_b32 v11, 16, v0
    v_cmp_eq_u32 vcc, 0, v11
    s_nop 1
    v_cndmask_b32 v12, v13, v12, vcc
    v_bfe_u32 v13, v0, 2, 2
    v_lshl_add_u32 v13, v15, 2, v13
    v_lshl_add_u32 v10, v13, 4, v12
    v_lshlrev_b32 v12, 2, v15
    v_sub_u32 v12, v14, v12
    v_mov_b32 v13, 0xf149f2ca
    v_cmp_le_i32 s[54:55], 0, v12
    v_cmp_le_i32 s[56:57], 1, v12
    v_cmp_le_i32 s[58:59], 2, v12
    v_cmp_le_i32 s[60:61], 3, v12
    v_cndmask_b32 v32, v13, 0, s[54:55]
    v_cndmask_b32 v96, 0, v13, s[54:55]
    v_cndmask_b32 v33, v13, 0, s[56:57]
    v_cndmask_b32 v97, 0, v13, s[56:57]
    v_cndmask_b32 v34, v13, 0, s[58:59]
    v_cndmask_b32 v98, 0, v13, s[58:59]
    v_cndmask_b32 v35, v13, 0, s[60:61]
    v_cndmask_b32 v99, 0, v13, s[60:61]
    v_cmp_le_i32 s[54:55], 8, v12
    v_cmp_le_i32 s[56:57], 9, v12
    v_cmp_le_i32 s[58:59], 10, v12
    v_cmp_le_i32 s[60:61], 11, v12
    v_cndmask_b32 v36, v13, 0, s[54:55]
    v_cndmask_b32 v100, 0, v13, s[54:55]
    v_cndmask_b32 v37, v13, 0, s[56:57]
    v_cndmask_b32 v101, 0, v13, s[56:57]
    v_cndmask_b32 v38, v13, 0, s[58:59]
    v_cndmask_b32 v102, 0, v13, s[58:59]
    v_cndmask_b32 v39, v13, 0, s[60:61]
    v_cndmask_b32 v103, 0, v13, s[60:61]
    v_cmp_le_i32 s[54:55], 16, v12
    v_cmp_le_i32 s[56:57], 17, v12
    v_cmp_le_i32 s[58:59], 18, v12
    v_cmp_le_i32 s[60:61], 19, v12
    v_cndmask_b32 v40, v13, 0, s[54:55]
    v_cndmask_b32 v104, 0, v13, s[54:55]
    v_cndmask_b32 v41, v13, 0, s[56:57]
    v_cndmask_b32 v105, 0, v13, s[56:57]
    v_cndmask_b32 v42, v13, 0, s[58:59]
    v_cndmask_b32 v106, 0, v13, s[58:59]
    v_cndmask_b32 v43, v13, 0, s[60:61]
    v_cndmask_b32 v107, 0, v13, s[60:61]
    v_cmp_le_i32 s[54:55], 24, v12
    v_cmp_le_i32 s[56:57], 25, v12
    v_cmp_le_i32 s[58:59], 26, v12
    v_cmp_le_i32 s[60:61], 27, v12
    v_cndmask_b32 v44, v13, 0, s[54:55]
    v_cndmask_b32 v108, 0, v13, s[54:55]
    v_cndmask_b32 v45, v13, 0, s[56:57]
    v_cndmask_b32 v109, 0, v13, s[56:57]
    v_cndmask_b32 v46, v13, 0, s[58:59]
    v_cndmask_b32 v110, 0, v13, s[58:59]
    v_cndmask_b32 v47, v13, 0, s[60:61]
    v_cndmask_b32 v111, 0, v13, s[60:61]
    s_add_u32 s6, s27, s5
    s_add_u32 s7, s44, s5
    s_lshl_b32 s27, s13, 16
    s_add_u32 s27, s27, s26
    s_add_u32 s27, s27, 0xf00000
    s_lshl_b32 s44, s13, 14
    s_lshr_b32 s47, s26, 1
    s_add_u32 s44, s44, s47
    s_add_u32 s44, s44, 0x1100000
    v_lshlrev_b32 v11, 4, v14
    v_mov_b32 v159, 0x71800000
    s_mov_b32 s62, 0
    s_mov_b32 s61, 0x07060302
    s_lshr_b32 s15, s26, 9
    s_and_b32 s75, s10, 3
    s_lshr_b32 s60, s10, 2
    s_lshl2_add_u32 s59, s72, s75
    s_lshl1_add_u32 s57, s74, s60
    s_lshl_b32 s57, s57, 6
    s_lshl_b32 s58, s74, 5
    s_add_u32 s58, s58, 1024
    v_and_b32 v140, 15, v0
    v_lshrrev_b32 v141, 4, v0
    v_bfrev_b32 v142, v141
    v_lshrrev_b32 v142, 26, v142
    v_add_u32 v142, s57, v142
    v_lshl_add_u32 v143, v141, 3, s58
    v_lshlrev_b32 v146, 4, v140
    v_mul_u32_u24 v161, 1280, v140
    v_add_u32 v160, v161, v142
    v_add_u32 v161, v161, v143
    v_lshlrev_b32 v163, 5, v140
    v_lshl_add_u32 v163, v141, 3, v163
    s_mul_i32 s32, s59, 20480
    s_add_u32 s33, s32, s3
    s_add_u32 s32, s32, 0x1180000
    s_cmp_eq_u32 s3, 0
    s_cselect_b32 s36, 0, 3145728
    s_add_u32 s32, s32, s36
    s_lshl_b32 s35, s74, 16
    s_lshl_b32 s34, s59, 9
    s_add_u32 s35, s35, s34
    s_add_u32 s35, s35, 0x1400000
    s_add_u32 s34, s35, s36
    s_lshl_b32 s36, s59, 8
    s_add_u32 s36, s36, 0x1de8000
    v_cmp_eq_u32 vcc, 0, v140
    s_nop 1
    v_cndmask_b32 v22, 0, v50, vcc
    v_cndmask_b32 v23, 0, v50, vcc
    v_cndmask_b32 v24, 0, v50, vcc
    v_cndmask_b32 v25, 0, v50, vcc
    v_cndmask_b32 v26, 0, v50, vcc
    v_cndmask_b32 v27, 0, v50, vcc
    s_lshr_b32 s50, s26, 10
    v_mov_b32 v154, s8
    v_mov_b32 v155, s50
    v_cmp_eq_u32 vcc, 0, v0
    s_nop 1
    v_cndmask_b32 v154, v154, v155, vcc
    v_mul_u32_u24 v154, 24, v154
    v_lshl_add_u32 v154, v0, 3, v154
    s_lshr_b32 s50, s13, 2
    v_add_lshl_u32 v154, v154, s50, 7
    s_lshl_b32 s50, s97, 16
    s_add_u32 s50, s50, 0x1e30800
    s_waitcnt vmcnt(0) lgkmcnt(0)
    s_cmp_eq_u32 s90, 0
    s_cbranch_scc1 Lao_nfl
    v_mov_b32 v156, s98
    v_lshlrev_b32 v157, 2, v0
    s_mov_b32 exec_lo, -1
    s_mov_b32 exec_hi, 0
    buffer_store_dword v156, v157, s[28:31], s90 offen sc1
    s_mov_b64 exec, -1
Lao_nfl:
    s_barrier
    v_add_u32 v12, s45, v1
    ds_write_b128 v12, v[48:51] offset:49536
    s_cmp_eq_u32 s9, 1
    s_cbranch_scc1 Lfix
Lfix_done:
    buffer_load_dwordx4 v[16:19], v160, s[64:67], s33 offen sc1
    s_mov_b32 exec_lo, 0x01000100
    s_mov_b32 exec_hi, 0x01000100
    buffer_load_dwordx4 v[22:25], v142, s[68:71], 0 offen
    buffer_load_dwordx2 v[26:27], v143, s[68:71], 0 offen
    s_mov_b64 exec, -1
    s_cmp_eq_u32 s3, 0
    s_cbranch_scc1 Lao_x1
    buffer_load_dwordx2 v[20:21], v163, s[20:23], s35 offen sc1
    buffer_load_dwordx4 v[112:115], v146, s[20:23], s36 offen sc1
    s_branch Lao_x2
Lao_x1:
    buffer_load_dwordx2 v[20:21], v161, s[64:67], s33 offen
Lao_x2:
    s_mov_b64 exec, 7
    s_mov_b32 s11, s50
    s_mov_b32 s12, 0
    s_mov_b64 s[88:89], exec
Lfw18:
    s_add_u32 s12, s12, 1
    s_and_b32 s99, s12, 7
    s_cbranch_scc1 Lfw18a
    s_mov_b64 exec, s[88:89]
    buffer_load_dword v155, v154, s[28:31], s11 offen sc0 sc1
    s_branch Lfw18b
Lfw18a:
    s_mov_b64 exec, s[88:89]
    buffer_load_dword v155, v154, s[28:31], s11 offen sc1
Lfw18b:
    s_waitcnt vmcnt(0)
    s_mov_b64 exec, s[88:89]
    v_cmp_ne_u32 s[88:89], s98, v155
    s_nop 0
    s_mov_b64 vcc, s[88:89]
    s_cbranch_vccz Lfw18c
    s_sleep 1
    s_cmp_lt_u32 s12, 0x40000
    s_cbranch_scc1 Lfw18
Lfw18c:
    s_mov_b64 exec, -1
    s_add_u32 m0, s45, 0
    s_nop 0
    buffer_load_dwordx4 v1, s[20:23], s24 offen sc1 lds
    s_add_u32 m0, s45, 8256
    s_add_u32 s47, s24, 32768
    buffer_load_dwordx4 v1, s[20:23], s47 offen sc1 lds
    s_add_u32 m0, s45, 16512
    s_nop 0
    buffer_load_dwordx4 v1, s[20:23], s25 offen sc1 lds
    buffer_load_dwordx4 v[2:5], v152, s[20:23], s6 offen sc1
    s_mov_b32 exec_hi, 0
    buffer_load_dwordx2 v[6:7], v11, s[20:23], s7 offen sc1
    s_mov_b32 exec_hi, -1
    s_add_u32 m0, s45, 24768
    s_add_u32 s47, s24, 2621440
    buffer_load_dwordx4 v1, s[20:23], s47 offen sc1 lds
    s_add_u32 m0, s45, 33024
    s_add_u32 s47, s24, 2654208
    buffer_load_dwordx4 v1, s[20:23], s47 offen sc1 lds
    s_add_u32 m0, s45, 41280
    s_add_u32 s47, s25, 2621440
    buffer_load_dwordx4 v1, s[20:23], s47 offen sc1 lds
    s_cmp_eq_u32 s3, 0
    s_cbranch_scc1 Lao_kq
    s_mov_b32 s47, 0
Lao_cnt:
    v_cmp_neq_f32 vcc, 0x41000000, v115
    s_cbranch_vccz Lao_cnt2
    buffer_load_dwordx4 v[112:115], v146, s[20:23], s36 offen sc0 sc1
    s_add_u32 s47, s47, 1
    s_waitcnt vmcnt(0)
    s_cmp_lt_u32 s47, 0x40000
    s_cbranch_scc1 Lao_cnt
Lao_cnt2:
    v_mul_f32 v116, 0x3acccccd, v112
    v_mul_f32 v118, 0x3acccccd, v113
    v_fma_f32 v118, -v116, v116, v118
    v_max_f32 v118, 0, v118
    v_cvt_pk_bf16_f32 v118, v118, v118
    v_and_b32 v118, 0xffff0000, v118
    v_add_f32 v118, 0x3727c5ac, v118
    v_cvt_pk_bf16_f32 v118, v118, v118
    v_and_b32 v118, 0xffff0000, v118
    v_sqrt_f32 v118, v118
    s_nop 0
    v_cvt_pk_bf16_f32 v118, v118, v118
    v_and_b32 v118, 0xffff0000, v118
    v_rcp_f32 v117, v118
    v_cvt_pk_bf16_f32 v116, v116, v116
    v_and_b32 v116, 0xffff0000, v116
    v_lshlrev_b32 v124, 16, v16
    v_and_b32 v125, 0xffff0000, v16
    v_lshlrev_b32 v130, 16, v17
    v_and_b32 v131, 0xffff0000, v17
    v_pk_add_f32 v[122:123], v[124:125], v[116:117] op_sel_hi:[1,0] neg_lo:[0,1] neg_hi:[0,1]
    v_pk_add_f32 v[128:129], v[130:131], v[116:117] op_sel_hi:[1,0] neg_lo:[0,1] neg_hi:[0,1]
    v_cvt_pk_bf16_f32 v120, v122, v123
    v_cvt_pk_bf16_f32 v126, v128, v129
    v_lshlrev_b32 v122, 16, v120
    v_and_b32 v123, 0xffff0000, v120
    v_lshlrev_b32 v128, 16, v126
    v_and_b32 v129, 0xffff0000, v126
    v_pk_mul_f32 v[122:123], v[122:123], v[116:117] op_sel:[0,1] op_sel_hi:[1,1]
    v_pk_mul_f32 v[128:129], v[128:129], v[116:117] op_sel:[0,1] op_sel_hi:[1,1]
    v_cvt_pk_bf16_f32 v120, v122, v123
    v_cvt_pk_bf16_f32 v126, v128, v129
    v_lshlrev_b32 v122, 16, v120
    v_and_b32 v123, 0xffff0000, v120
    v_lshlrev_b32 v128, 16, v126
    v_and_b32 v129, 0xffff0000, v126
    v_pk_add_f32 v[122:123], v[122:123], v[124:125]
    v_pk_add_f32 v[128:129], v[128:129], v[130:131]
    v_cvt_pk_bf16_f32 v16, v122, v123
    v_cvt_pk_bf16_f32 v17, v128, v129
    v_lshlrev_b32 v124, 16, v18
    v_and_b32 v125, 0xffff0000, v18
    v_lshlrev_b32 v130, 16, v19
    v_and_b32 v131, 0xffff0000, v19
    v_pk_add_f32 v[122:123], v[124:125], v[116:117] op_sel_hi:[1,0] neg_lo:[0,1] neg_hi:[0,1]
    v_pk_add_f32 v[128:129], v[130:131], v[116:117] op_sel_hi:[1,0] neg_lo:[0,1] neg_hi:[0,1]
    v_cvt_pk_bf16_f32 v120, v122, v123
    v_cvt_pk_bf16_f32 v126, v128, v129
    v_lshlrev_b32 v122, 16, v120
    v_and_b32 v123, 0xffff0000, v120
    v_lshlrev_b32 v128, 16, v126
    v_and_b32 v129, 0xffff0000, v126
    v_pk_mul_f32 v[122:123], v[122:123], v[116:117] op_sel:[0,1] op_sel_hi:[1,1]
    v_pk_mul_f32 v[128:129], v[128:129], v[116:117] op_sel:[0,1] op_sel_hi:[1,1]
    v_cvt_pk_bf16_f32 v120, v122, v123
    v_cvt_pk_bf16_f32 v126, v128, v129
    v_lshlrev_b32 v122, 16, v120
    v_and_b32 v123, 0xffff0000, v120
    v_lshlrev_b32 v128, 16, v126
    v_and_b32 v129, 0xffff0000, v126
    v_pk_add_f32 v[122:123], v[122:123], v[124:125]
    v_pk_add_f32 v[128:129], v[128:129], v[130:131]
    v_cvt_pk_bf16_f32 v18, v122, v123
    v_cvt_pk_bf16_f32 v19, v128, v129
    v_lshlrev_b32 v124, 16, v20
    v_and_b32 v125, 0xffff0000, v20
    v_lshlrev_b32 v130, 16, v21
    v_and_b32 v131, 0xffff0000, v21
    v_pk_add_f32 v[122:123], v[124:125], v[116:117] op_sel_hi:[1,0] neg_lo:[0,1] neg_hi:[0,1]
    v_pk_add_f32 v[128:129], v[130:131], v[116:117] op_sel_hi:[1,0] neg_lo:[0,1] neg_hi:[0,1]
    v_cvt_pk_bf16_f32 v120, v122, v123
    v_cvt_pk_bf16_f32 v126, v128, v129
    v_lshlrev_b32 v122, 16, v120
    v_and_b32 v123, 0xffff0000, v120
    v_lshlrev_b32 v128, 16, v126
    v_and_b32 v129, 0xffff0000, v126
    v_pk_mul_f32 v[122:123], v[122:123], v[116:117] op_sel:[0,1] op_sel_hi:[1,1]
    v_pk_mul_f32 v[128:129], v[128:129], v[116:117] op_sel:[0,1] op_sel_hi:[1,1]
    v_cvt_pk_bf16_f32 v120, v122, v123
    v_cvt_pk_bf16_f32 v126, v128, v129
    v_lshlrev_b32 v122, 16, v120
    v_and_b32 v123, 0xffff0000, v120
    v_lshlrev_b32 v128, 16, v126
    v_and_b32 v129, 0xffff0000, v126
    v_pk_add_f32 v[122:123], v[122:123], v[124:125]
    v_pk_add_f32 v[128:129], v[128:129], v[130:131]
    v_cvt_pk_bf16_f32 v20, v122, v123
    v_cvt_pk_bf16_f32 v21, v128, v129
    s_lshl_b32 s47, s59, 4
    v_add_u32 v140, s47, v140
    v_lshlrev_b32 v142, 3, v142
    v_and_b32 v144, 0xfffffff0, v143
    v_lshlrev_b32 v144, 3, v144
    v_and_or_b32 v143, v143, 8, v144
    s_waitcnt vmcnt(0)
Lao_kq:
    s_waitcnt vmcnt(3) lgkmcnt(0)
    s_barrier
    s_cmp_eq_u32 s3, 0
    s_cbranch_scc1 Lao_nosel
    v_mov_b32 v12, 160192
    s_lshr_b32 s47, s26, 4
    v_add_u32 v13, s47, v14
    s_barrier
    ds_read_b128 v[48:51], v12
    ds_read_b128 v[52:55], v12 offset:16
    v_mov_b32 v56, -1
    v_mov_b32 v57, -1
    s_waitcnt lgkmcnt(0)
    v_cmp_eq_u32 vcc, v48, v13
    v_cmp_eq_u32 s[48:49], v48, v140
    s_nop 0
    v_cndmask_b32 v56, v56, 0, vcc
    v_cndmask_b32 v57, v57, 0, s[48:49]
    v_cmp_eq_u32 vcc, v49, v13
    v_cmp_eq_u32 s[48:49], v49, v140
    s_nop 0
    v_cndmask_b32 v56, v56, 1, vcc
    v_cndmask_b32 v57, v57, 1, s[48:49]
    v_cmp_eq_u32 vcc, v50, v13
    v_cmp_eq_u32 s[48:49], v50, v140
    s_nop 0
    v_cndmask_b32 v56, v56, 2, vcc
    v_cndmask_b32 v57, v57, 2, s[48:49]
    v_cmp_eq_u32 vcc, v51, v13
    v_cmp_eq_u32 s[48:49], v51, v140
    s_nop 0
    v_cndmask_b32 v56, v56, 3, vcc
    v_cndmask_b32 v57, v57, 3, s[48:49]
    v_cmp_eq_u32 vcc, v52, v13
    v_cmp_eq_u32 s[48:49], v52, v140
    s_nop 0
    v_cndmask_b32 v56, v56, 4, vcc
    v_cndmask_b32 v57, v57, 4, s[48:49]
    v_cmp_eq_u32 vcc, v53, v13
    v_cmp_eq_u32 s[48:49], v53, v140
    s_nop 0
    v_cndmask_b32 v56, v56, 5, vcc
    v_cndmask_b32 v57, v57, 5, s[48:49]
    v_cmp_eq_u32 vcc, v54, v13
    v_cmp_eq_u32 s[48:49], v54, v140
    s_nop 0
    v_cndmask_b32 v56, v56, 6, vcc
    v_cndmask_b32 v57, v57, 6, s[48:49]
    v_cmp_eq_u32 vcc, v55, v13
    v_cmp_eq_u32 s[48:49], v55, v140
    s_nop 0
    v_cndmask_b32 v56, v56, 7, vcc
    v_cndmask_b32 v57, v57, 7, s[48:49]
    v_cmp_le_i32 vcc, 0, v57
    s_nop 0
    s_and_saveexec_b64 s[48:49], vcc
    s_cbranch_execz Lao_nox
    v_lshl_add_u32 v142, v57, 4, v142
    v_lshl_add_u32 v143, v57, 4, v143
    s_mov_b32 s47, 0x1df6000
    buffer_load_dwordx4 v[16:19], v142, s[20:23], s47 offen sc1
    buffer_load_dwordx2 v[20:21], v143, s[20:23], s47 offen sc1
Lao_nox:
    s_mov_b64 exec, s[48:49]
    v_cmp_le_i32 vcc, 0, v56
    s_nop 0
    s_and_saveexec_b64 s[48:49], vcc
    s_cbranch_execz Lao_noq
    v_lshl_add_u32 v12, v56, 4, v12
    v_lshl_add_u32 v13, v15, 7, v12
    ds_read_b128 v[2:5], v13 offset:32
    s_lshl_b32 s47, s16, 3
    v_add_u32 v12, s47, v12
    s_mov_b32 exec_hi, 0
    ds_read_b64 v[6:7], v12 offset:288
    s_waitcnt lgkmcnt(0)
Lao_noq:
    s_mov_b64 exec, s[48:49]
Lao_nosel:
    ds_read_b128 v[80:83], v8 offset:4096
    ds_read_b64 v[84:85], v9 offset:4096
    ds_read_b128 v[88:91], v8 offset:0
    ds_read_b64 v[92:93], v9 offset:0
    s_waitcnt lgkmcnt(2)
    v_mfma_f32_32x32x16_bf16 v[48:63], v[80:83], v[2:5], v[32:47]
    v_mfma_f32_32x32x8_bf16 v[48:63], v[84:85], v[6:7], v[48:63]
    s_nop 11
    v_max_f32 v12, v48, v49
    v_max_f32 v13, v50, v51
    v_max3_f32 v12, v52, v53, v12
    v_max3_f32 v13, v54, v55, v13
    v_max3_f32 v12, v56, v57, v12
    v_max3_f32 v13, v58, v59, v13
    v_max3_f32 v12, v60, v61, v12
    v_max3_f32 v13, v62, v63, v13
Latt_havemax:
    v_max_f32 v12, v12, v13
    v_mov_b32 v13, v12
    s_nop 1
    v_permlane32_swap_b32 v12, v13
    v_max_f32 v12, v12, v13
    v_xor_b32 v154, 0x80000000, v12
    v_and_b32 v155, 0xffff0000, v154
    v_sub_f32 v154, v154, v155
    v_and_b32 v156, 0xffff0000, v154
    v_sub_f32 v154, v154, v156
    s_mov_b32 exec_lo, 0
    v_or_b32 v6, 0x3f80, v155
    v_perm_b32 v7, v154, v156, s61
    s_mov_b32 exec_lo, -1
    v_sub_f32 v48, v48, v12
    v_sub_f32 v49, v49, v12
    v_sub_f32 v50, v50, v12
    v_sub_f32 v51, v51, v12
    v_sub_f32 v52, v52, v12
    v_sub_f32 v53, v53, v12
    v_sub_f32 v54, v54, v12
    v_sub_f32 v55, v55, v12
    v_sub_f32 v56, v56, v12
    v_sub_f32 v57, v57, v12
    v_sub_f32 v58, v58, v12
    v_sub_f32 v59, v59, v12
    v_sub_f32 v60, v60, v12
    v_sub_f32 v61, v61, v12
    v_sub_f32 v62, v62, v12
    v_sub_f32 v63, v63, v12
    s_cmp_eq_u32 s62, 1
    s_cbranch_scc1 Latt_havev
    s_cmp_lg_u32 s3, 0
    s_cbranch_scc1 Latt_v2
    s_waitcnt vmcnt(0)
Latt_v2:
    s_barrier
Latt_havev:
    s_cmp_lt_u32 s10, 4
    s_cbranch_scc1 Latt_npa
    s_setprio 1
Latt_npa:
    ds_read_b64_tr_b16 v[136:137], v10 offset:4096
    ds_read_b64_tr_b16 v[138:139], v10 offset:4224
    ds_read_b64_tr_b16 v[140:141], v10 offset:4352
    ds_read_b64_tr_b16 v[142:143], v10 offset:4480
    v_exp_f32 v48, v48
    v_exp_f32 v49, v49
    ds_read_b64_tr_b16 v[144:145], v10 offset:0
    ds_read_b64_tr_b16 v[146:147], v10 offset:128
    ds_read_b64_tr_b16 v[148:149], v10 offset:256
    ds_read_b64_tr_b16 v[150:151], v10 offset:384
    v_exp_f32 v50, v50
    v_exp_f32 v51, v51
    v_exp_f32 v52, v52
    s_waitcnt lgkmcnt(4)
    v_mfma_f32_32x32x16_bf16 v[64:79], v[88:91], v[2:5], v[96:111]
    ds_read_b128 v[80:83], v8 offset:3584
    ds_read_b64 v[84:85], v9 offset:3584
    v_exp_f32 v53, v53
    v_exp_f32 v54, v54
    v_exp_f32 v55, v55
    v_cvt_pk_bf16_f32 v128, v48, v49
    v_cvt_pk_bf16_f32 v129, v50, v51
    v_cvt_pk_bf16_f32 v130, v52, v53
    v_cvt_pk_bf16_f32 v131, v54, v55
    v_mfma_f32_32x32x8_bf16 v[64:79], v[92:93], v[6:7], v[64:79]
    v_exp_f32 v56, v56
    v_exp_f32 v57, v57
    v_exp_f32 v58, v58
    v_exp_f32 v59, v59
    v_mfma_f32_32x32x16_bf16 v[112:127], v[136:139], v[128:131], 0
    v_exp_f32 v60, v60
    v_exp_f32 v61, v61
    v_exp_f32 v62, v62
    v_exp_f32 v63, v63
    v_cvt_pk_bf16_f32 v132, v56, v57
    v_cvt_pk_bf16_f32 v133, v58, v59
    v_cvt_pk_bf16_f32 v134, v60, v61
    v_cvt_pk_bf16_f32 v135, v62, v63
    v_exp_f32 v64, v64
    v_exp_f32 v65, v65
    v_mfma_f32_32x32x16_bf16 v[112:127], v[140:143], v[132:135], v[112:127]
    ds_read_b64_tr_b16 v[136:137], v10 offset:3584
    ds_read_b64_tr_b16 v[138:139], v10 offset:3712
    ds_read_b64_tr_b16 v[140:141], v10 offset:3840
    ds_read_b64_tr_b16 v[142:143], v10 offset:3968
    v_exp_f32 v66, v66
    v_exp_f32 v67, v67
    v_exp_f32 v68, v68
    s_waitcnt lgkmcnt(4)
    v_mfma_f32_32x32x16_bf16 v[48:63], v[80:83], v[2:5], 0
    ds_read_b128 v[88:91], v8 offset:3072
    ds_read_b64 v[92:93], v9 offset:3072
    v_exp_f32 v69, v69
    v_exp_f32 v70, v70
    v_exp_f32 v71, v71
    v_cvt_pk_bf16_f32 v128, v64, v65
    v_cvt_pk_bf16_f32 v129, v66, v67
    v_cvt_pk_bf16_f32 v130, v68, v69
    v_cvt_pk_bf16_f32 v131, v70, v71
    v_mfma_f32_32x32x8_bf16 v[48:63], v[84:85], v[6:7], v[48:63]
    v_exp_f32 v72, v72
    v_exp_f32 v73, v73
    v_exp_f32 v74, v74
    v_exp_f32 v75, v75
    v_mfma_f32_32x32x16_bf16 v[112:127], v[144:147], v[128:131], v[112:127]
    v_exp_f32 v76, v76
    v_exp_f32 v77, v77
    v_exp_f32 v78, v78
    v_exp_f32 v79, v79
    v_cvt_pk_bf16_f32 v132, v72, v73
    v_cvt_pk_bf16_f32 v133, v74, v75
    v_cvt_pk_bf16_f32 v134, v76, v77
    v_cvt_pk_bf16_f32 v135, v78, v79
    s_cmp_lt_u32 s15, 1
    s_cbranch_scc1 Latt_exit1
    v_exp_f32 v48, v48
    v_exp_f32 v49, v49
    v_mfma_f32_32x32x16_bf16 v[112:127], v[148:151], v[132:135], v[112:127]
    ds_read_b64_tr_b16 v[144:145], v10 offset:3072
    ds_read_b64_tr_b16 v[146:147], v10 offset:3200
    ds_read_b64_tr_b16 v[148:149], v10 offset:3328
    ds_read_b64_tr_b16 v[150:151], v10 offset:3456
    v_exp_f32 v50, v50
    v_exp_f32 v51, v51
    v_exp_f32 v52, v52
    s_waitcnt lgkmcnt(4)
    v_mfma_f32_32x32x16_bf16 v[64:79], v[88:91], v[2:5], 0
    ds_read_b128 v[80:83], v8 offset:2560
    ds_read_b64 v[84:85], v9 offset:2560
    v_exp_f32 v53, v53
    v_exp_f32 v54, v54
    v_exp_f32 v55, v55
    v_cvt_pk_bf16_f32 v128, v48, v49
    v_cvt_pk_bf16_f32 v129, v50, v51
    v_cvt_pk_bf16_f32 v130, v52, v53
    v_cvt_pk_bf16_f32 v131, v54, v55
    v_mfma_f32_32x32x8_bf16 v[64:79], v[92:93], v[6:7], v[64:79]
    v_exp_f32 v56, v56
    v_exp_f32 v57, v57
    v_exp_f32 v58, v58
    v_exp_f32 v59, v59
    v_mfma_f32_32x32x16_bf16 v[112:127], v[136:139], v[128:131], v[112:127]
    v_exp_f32 v60, v60
    v_exp_f32 v61, v61
    v_exp_f32 v62, v62
    v_exp_f32 v63, v63
    v_cvt_pk_bf16_f32 v132, v56, v57
    v_cvt_pk_bf16_f32 v133, v58, v59
    v_cvt_pk_bf16_f32 v134, v60, v61
    v_cvt_pk_bf16_f32 v135, v62, v63
    s_cmp_lt_u32 s15, 2
    s_cbranch_scc1 Latt_exit0
    v_exp_f32 v64, v64
    v_exp_f32 v65, v65
    v_mfma_f32_32x32x16_bf16 v[112:127], v[140:143], v[132:135], v[112:127]
    ds_read_b64_tr_b16 v[136:137], v10 offset:2560
    ds_read_b64_tr_b16 v[138:139], v10 offset:2688
    ds_read_b64_tr_b16 v[140:141], v10 offset:2816
    ds_read_b64_tr_b16 v[142:143], v10 offset:2944
    v_exp_f32 v66, v66
    v_exp_f32 v67, v67
    v_exp_f32 v68, v68
    s_waitcnt lgkmcnt(4)
    v_mfma_f32_32x32x16_bf16 v[48:63], v[80:83], v[2:5], 0
    ds_read_b128 v[88:91], v8 offset:2048
    ds_read_b64 v[92:93], v9 offset:2048
    v_exp_f32 v69, v69
    v_exp_f32 v70, v70
    v_exp_f32 v71, v71
    v_cvt_pk_bf16_f32 v128, v64, v65
    v_cvt_pk_bf16_f32 v129, v66, v67
    v_cvt_pk_bf16_f32 v130, v68, v69
    v_cvt_pk_bf16_f32 v131, v70, v71
    v_mfma_f32_32x32x8_bf16 v[48:63], v[84:85], v[6:7], v[48:63]
    v_exp_f32 v72, v72
    v_exp_f32 v73, v73
    v_exp_f32 v74, v74
    v_exp_f32 v75, v75
    v_mfma_f32_32x32x16_bf16 v[112:127], v[144:147], v[128:131], v[112:127]
    v_exp_f32 v76, v76
    v_exp_f32 v77, v77
    v_exp_f32 v78, v78
    v_exp_f32 v79, v79
    v_cvt_pk_bf16_f32 v132, v72, v73
    v_cvt_pk_bf16_f32 v133, v74, v75
    v_cvt_pk_bf16_f32 v134, v76, v77
    v_cvt_pk_bf16_f32 v135, v78, v79
    s_cmp_lt_u32 s15, 3
    s_cbranch_scc1 Latt_exit1
    v_exp_f32 v48, v48
    v_exp_f32 v49, v49
    v_mfma_f32_32x32x16_bf16 v[112:127], v[148:151], v[132:135], v[112:127]
    ds_read_b64_tr_b16 v[144:145], v10 offset:2048
    ds_read_b64_tr_b16 v[146:147], v10 offset:2176
    ds_read_b64_tr_b16 v[148:149], v10 offset:2304
    ds_read_b64_tr_b16 v[150:151], v10 offset:2432
    v_exp_f32 v50, v50
    v_exp_f32 v51, v51
    v_exp_f32 v52, v52
    s_waitcnt lgkmcnt(4)
    v_mfma_f32_32x32x16_bf16 v[64:79], v[88:91], v[2:5], 0
    ds_read_b128 v[80:83], v8 offset:1536
    ds_read_b64 v[84:85], v9 offset:1536
    v_exp_f32 v53, v53
    v_exp_f32 v54, v54
    v_exp_f32 v55, v55
    v_cvt_pk_bf16_f32 v128, v48, v49
    v_cvt_pk_bf16_f32 v129, v50, v51
    v_cvt_pk_bf16_f32 v130, v52, v53
    v_cvt_pk_bf16_f32 v131, v54, v55
    v_mfma_f32_32x32x8_bf16 v[64:79], v[92:93], v[6:7], v[64:79]
    v_exp_f32 v56, v56
    v_exp_f32 v57, v57
    v_exp_f32 v58, v58
    v_exp_f32 v59, v59
    v_mfma_f32_32x32x16_bf16 v[112:127], v[136:139], v[128:131], v[112:127]
    v_exp_f32 v60, v60
    v_exp_f32 v61, v61
    v_exp_f32 v62, v62
    v_exp_f32 v63, v63
    v_cvt_pk_bf16_f32 v132, v56, v57
    v_cvt_pk_bf16_f32 v133, v58, v59
    v_cvt_pk_bf16_f32 v134, v60, v61
    v_cvt_pk_bf16_f32 v135, v62, v63
    s_cmp_lt_u32 s15, 4
    s_cbranch_scc1 Latt_exit0
    v_exp_f32 v64, v64
    v_exp_f32 v65, v65
    v_mfma_f32_32x32x16_bf16 v[112:127], v[140:143], v[132:135], v[112:127]
    ds_read_b64_tr_b16 v[136:137], v10 offset:1536
    ds_read_b64_tr_b16 v[138:139], v10 offset:1664
    ds_read_b64_tr_b16 v[140:141], v10 offset:1792
    ds_read_b64_tr_b16 v[142:143], v10 offset:1920
    v_exp_f32 v66, v66
    v_exp_f32 v67, v67
    v_exp_f32 v68, v68
    s_waitcnt lgkmcnt(4)
    v_mfma_f32_32x32x16_bf16 v[48:63], v[80:83], v[2:5], 0
    ds_read_b128 v[88:91], v8 offset:1024
    ds_read_b64 v[92:93], v9 offset:1024
    v_exp_f32 v69, v69
    v_exp_f32 v70, v70
    v_exp_f32 v71, v71
    v_cvt_pk_bf16_f32 v128, v64, v65
    v_cvt_pk_bf16_f32 v129, v66, v67
    v_cvt_pk_bf16_f32 v130, v68, v69
    v_cvt_pk_bf16_f32 v131, v70, v71
    v_mfma_f32_32x32x8_bf16 v[48:63], v[84:85], v[6:7], v[48:63]
    v_exp_f32 v72, v72
    v_exp_f32 v73, v73
    v_exp_f32 v74, v74
    v_exp_f32 v75, v75
    v_mfma_f32_32x32x16_bf16 v[112:127], v[144:147], v[128:131], v[112:127]
    v_exp_f32 v76, v76
    v_exp_f32 v77, v77
    v_exp_f32 v78, v78
    v_exp_f32 v79, v79
    v_cvt_pk_bf16_f32 v132, v72, v73
    v_cvt_pk_bf16_f32 v133, v74, v75
    v_cvt_pk_bf16_f32 v134, v76, v77
    v_cvt_pk_bf16_f32 v135, v78, v79
    s_cmp_lt_u32 s15, 5
    s_cbranch_scc1 Latt_exit1
    v_exp_f32 v48, v48
    v_exp_f32 v49, v49
    v_mfma_f32_32x32x16_bf16 v[112:127], v[148:151], v[132:135], v[112:127]
    ds_read_b64_tr_b16 v[144:145], v10 offset:1024
    ds_read_b64_tr_b16 v[146:147], v10 offset:1152
    ds_read_b64_tr_b16 v[148:149], v10 offset:1280
    ds_read_b64_tr_b16 v[150:151], v10 offset:1408
    v_exp_f32 v50, v50
    v_exp_f32 v51, v51
    v_exp_f32 v52, v52
    s_waitcnt lgkmcnt(4)
    v_mfma_f32_32x32x16_bf16 v[64:79], v[88:91], v[2:5], 0
    ds_read_b128 v[80:83], v8 offset:512
    ds_read_b64 v[84:85], v9 offset:512
    v_exp_f32 v53, v53
    v_exp_f32 v54, v54
    v_exp_f32 v55, v55
    v_cvt_pk_bf16_f32 v128, v48, v49
    v_cvt_pk_bf16_f32 v129, v50, v51
    v_cvt_pk_bf16_f32 v130, v52, v53
    v_cvt_pk_bf16_f32 v131, v54, v55
    v_mfma_f32_32x32x8_bf16 v[64:79], v[92:93], v[6:7], v[64:79]
    v_exp_f32 v56, v56
    v_exp_f32 v57, v57
    v_exp_f32 v58, v58
    v_exp_f32 v59, v59
    v_mfma_f32_32x32x16_bf16 v[112:127], v[136:139], v[128:131], v[112:127]
    v_exp_f32 v60, v60
    v_exp_f32 v61, v61
    v_exp_f32 v62, v62
    v_exp_f32 v63, v63
    v_cvt_pk_bf16_f32 v132, v56, v57
    v_cvt_pk_bf16_f32 v133, v58, v59
    v_cvt_pk_bf16_f32 v134, v60, v61
    v_cvt_pk_bf16_f32 v135, v62, v63
    s_cmp_lt_u32 s15, 6
    s_cbranch_scc1 Latt_exit0
    v_exp_f32 v64, v64
    v_exp_f32 v65, v65
    v_mfma_f32_32x32x16_bf16 v[112:127], v[140:143], v[132:135], v[112:127]
    ds_read_b64_tr_b16 v[136:137], v10 offset:512
    ds_read_b64_tr_b16 v[138:139], v10 offset:640
    ds_read_b64_tr_b16 v[140:141], v10 offset:768
    ds_read_b64_tr_b16 v[142:143], v10 offset:896
    v_exp_f32 v66, v66
    v_exp_f32 v67, v67
    v_exp_f32 v68, v68
    s_waitcnt lgkmcnt(4)
    v_mfma_f32_32x32x16_bf16 v[48:63], v[80:83], v[2:5], 0
    v_exp_f32 v69, v69
    v_exp_f32 v70, v70
    v_exp_f32 v71, v71
    v_cvt_pk_bf16_f32 v128, v64, v65
    v_cvt_pk_bf16_f32 v129, v66, v67
    v_cvt_pk_bf16_f32 v130, v68, v69
    v_cvt_pk_bf16_f32 v131, v70, v71
    v_mfma_f32_32x32x8_bf16 v[48:63], v[84:85], v[6:7], v[48:63]
    v_exp_f32 v72, v72
    v_exp_f32 v73, v73
    v_exp_f32 v74, v74
    v_exp_f32 v75, v75
    v_mfma_f32_32x32x16_bf16 v[112:127], v[144:147], v[128:131], v[112:127]
    v_exp_f32 v76, v76
    v_exp_f32 v77, v77
    v_exp_f32 v78, v78
    v_exp_f32 v79, v79
    v_cvt_pk_bf16_f32 v132, v72, v73
    v_cvt_pk_bf16_f32 v133, v74, v75
    v_cvt_pk_bf16_f32 v134, v76, v77
    v_cvt_pk_bf16_f32 v135, v78, v79
    s_cmp_lt_u32 s15, 7
    s_cbranch_scc1 Latt_exit1
    v_exp_f32 v48, v48
    v_exp_f32 v49, v49
    v_mfma_f32_32x32x16_bf16 v[112:127], v[148:151], v[132:135], v[112:127]
    v_exp_f32 v50, v50
    v_exp_f32 v51, v51
    v_exp_f32 v52, v52
    s_waitcnt lgkmcnt(0)
    v_exp_f32 v53, v53
    v_exp_f32 v54, v54
    v_exp_f32 v55, v55
    v_cvt_pk_bf16_f32 v128, v48, v49
    v_cvt_pk_bf16_f32 v129, v50, v51
    v_cvt_pk_bf16_f32 v130, v52, v53
    v_cvt_pk_bf16_f32 v131, v54, v55
    v_exp_f32 v56, v56
    v_exp_f32 v57, v57
    v_exp_f32 v58, v58
    v_exp_f32 v59, v59
    v_mfma_f32_32x32x16_bf16 v[112:127], v[136:139], v[128:131], v[112:127]
    v_exp_f32 v60, v60
    v_exp_f32 v61, v61
    v_exp_f32 v62, v62
    v_exp_f32 v63, v63
    v_cvt_pk_bf16_f32 v132, v56, v57
    v_cvt_pk_bf16_f32 v133, v58, v59
    v_cvt_pk_bf16_f32 v134, v60, v61
    v_cvt_pk_bf16_f32 v135, v62, v63
Latt_exit0:
    s_nop 1
    v_mfma_f32_32x32x16_bf16 v[112:127], v[140:143], v[132:135], v[112:127]
Latt_join:
    s_setprio 0
    s_waitcnt lgkmcnt(0)
    s_nop 9
    v_add_f32 v153, |v112|, v124
    v_add_f32 v158, |v113|, |v114|
    v_add_f32 v158, |v115|, v158
    v_add_f32 v153, |v116|, v153
    v_add_f32 v158, |v117|, v158
    v_add_f32 v153, |v118|, v153
    v_add_f32 v158, |v119|, v158
    v_add_f32 v153, |v120|, v153
    v_add_f32 v158, |v121|, v158
    v_add_f32 v153, |v122|, v153
    v_add_f32 v158, |v123|, v158
    v_add_f32 v153, v153, v158
    v_cmp_nlt_f32 vcc, v153, v159
    s_cmp_eq_u32 s62, 1
    s_cbranch_scc1 Latt_out
    s_cbranch_vccnz Latt_exact
Latt_out:
    v_rcp_f32 v153, v124
    s_nop 0
    v_mul_f32 v112, v112, v153
    v_mul_f32 v113, v113, v153
    v_mul_f32 v114, v114, v153
    v_mul_f32 v115, v115, v153
    v_mul_f32 v116, v116, v153
    v_mul_f32 v117, v117, v153
    v_mul_f32 v118, v118, v153
    v_mul_f32 v119, v119, v153
    v_mul_f32 v120, v120, v153
    v_mul_f32 v121, v121, v153
    v_mul_f32 v122, v122, v153
    v_mul_f32 v123, v123, v153
    v_cvt_pk_bf16_f32 v128, v112, v113
    v_cvt_pk_bf16_f32 v129, v114, v115
    v_cvt_pk_bf16_f32 v130, v116, v117
    v_cvt_pk_bf16_f32 v131, v118, v119
    v_cvt_pk_bf16_f32 v132, v120, v121
    v_cvt_pk_bf16_f32 v133, v122, v123
    v_min_u32 v128, -2, v128
    v_min_u32 v129, -2, v129
    v_min_u32 v130, -2, v130
    v_min_u32 v131, -2, v131
    v_min_u32 v132, -2, v132
    v_min_u32 v133, -2, v133
    v_permlane32_swap_b32 v128, v130
    v_permlane32_swap_b32 v129, v131
    buffer_store_dwordx4 v[128:131], v152, s[20:23], s27 offen sc1
    s_mov_b32 exec_hi, 0
    v_lshlrev_b32 v11, 3, v14
    buffer_store_dwordx2 v[132:133], v11, s[20:23], s44 offen sc1
    s_mov_b64 exec, -1
    v_and_b32 v28, 15, v0
    v_lshrrev_b32 v29, 4, v0
    v_lshlrev_b32 v34, 4, v28
    s_lshl_b32 s78, s59, 8
    s_lshl_b32 s79, s60, 18
    s_add_u32 s78, s78, s79
    s_add_u32 s78, s78, 0xf00000
    s_lshl_b32 s4, s73, 19
    s_add_u32 s4, s4, s78
    s_add_u32 s73, s73, 1
    s_and_b32 s73, s73, 3
    s_lshl_b32 s5, s73, 19
    s_add_u32 s5, s5, s78
    s_add_u32 s73, s73, 1
    s_and_b32 s73, s73, 3
    s_lshl_b32 s6, s73, 19
    s_add_u32 s6, s6, s78
    s_add_u32 s73, s73, 1
    s_and_b32 s73, s73, 3
    s_lshl_b32 s7, s73, 19
    s_add_u32 s7, s7, s78
    s_lshl_b32 s8, s59, 7
    s_add_u32 s8, s8, s79
    s_add_u32 s8, s8, 0x1100000
    s_add_u32 s40, s8, 0x4000
    s_add_u32 s41, s8, 0x20000
    s_add_u32 s42, s8, 0x24000
    v_lshlrev_b32 v9, 15, v29
    v_lshl_add_u32 v9, v28, 3, v9
    s_mul_i32 s36, s60, 10240
    s_add_u32 s36, s36, 57792
    s_lshl_b32 s37, s60, 11
    s_xor_b32 s38, s37, 2048
    s_add_u32 s37, s37, s36
    s_add_u32 s38, s38, s36
    v_add_u32 v14, s38, v1
    v_add_u32 v4, s36, v1
    v_add_u32 v12, s37, v1
    v_add_u32 v13, 61440, v12
    v_add_u32 v15, 61440, v14
    v_add_u32 v5, 61440, v4
    v_lshlrev_b32 v2, 15, v29
    v_add_u32 v2, v2, v34
    v_add_u32 v7, 131072, v2
    v_and_b32 v3, 3, v0
    v_cmp_eq_u32 s[90:91], 1, v3
    v_cmp_eq_u32 s[92:93], 2, v3
    v_cmp_eq_u32 s[94:95], 3, v3
    s_lshl_b32 s39, s10, 8
    v_add_u32 v11, s39, v34
    v_lshl_add_u32 v8, v29, 2, v11
    s_waitcnt vmcnt(2)
    v_lshlrev_b32 v36, 16, v16
    v_and_b32 v37, 0xffff0000, v16
    v_lshlrev_b32 v38, 16, v17
    v_and_b32 v39, 0xffff0000, v17
    v_lshlrev_b32 v40, 16, v18
    v_and_b32 v41, 0xffff0000, v18
    v_lshlrev_b32 v42, 16, v19
    v_and_b32 v43, 0xffff0000, v19
    v_lshlrev_b32 v44, 16, v20
    v_and_b32 v45, 0xffff0000, v20
    v_lshlrev_b32 v46, 16, v21
    v_and_b32 v47, 0xffff0000, v21
    s_waitcnt vmcnt(0)
    s_barrier
    s_mov_b32 s43, 0
    buffer_load_dwordx4 v[48:51], v2, s[20:23], s4 offen sc1
    buffer_load_dwordx4 v[52:55], v7, s[20:23], s4 offen sc1
    ds_read_b128 v[100:103], v12 offset:0
    ds_read_b128 v[104:107], v12 offset:1024
    ds_read_b128 v[108:111], v14 offset:0
    ds_read_b128 v[112:115], v14 offset:1024
    ds_read_b128 v[116:119], v4 offset:4096
    ds_read_b128 v[120:123], v12 offset:5120
    ds_read_b128 v[124:127], v12 offset:6144
    ds_read_b128 v[128:131], v14 offset:5120
    ds_read_b128 v[132:135], v14 offset:6144
    ds_read_b128 v[136:139], v4 offset:9216
    ds_read_b128 v[140:143], v12 offset:20480
    ds_read_b128 v[144:147], v12 offset:21504
    ds_read_b128 v[148:151], v14 offset:20480
    ds_read_b128 v[152:155], v14 offset:21504
    ds_read_b128 v[156:159], v4 offset:24576
    s_waitcnt vmcnt(1)
    buffer_load_dwordx4 v[56:59], v2, s[20:23], s5 offen sc1
    v_max3_u32 v6, v48, v49, v50
    v_max_u32 v6, v6, v51
    v_cmp_eq_u32 vcc, -1, v6
    s_cbranch_vccnz Lop_retry1
Lop_ok1:
    s_waitcnt lgkmcnt(10)
    v_mfma_f32_16x16x32_bf16 v[28:31], v[100:103], v[48:51], 0
    v_mfma_f32_16x16x32_bf16 v[32:35], v[104:107], v[48:51], 0
    ds_read_b128 v[100:103], v12 offset:25600
    v_mfma_f32_16x16x32_bf16 v[88:91], v[108:111], v[48:51], 0
    ds_read_b128 v[104:107], v12 offset:26624
    v_mfma_f32_16x16x32_bf16 v[92:95], v[112:115], v[48:51], 0
    ds_read_b128 v[108:111], v14 offset:25600
    v_mfma_f32_16x16x32_bf16 v[96:99], v[116:119], v[48:51], 0
    ds_read_b128 v[112:115], v14 offset:26624
    ds_read_b128 v[116:119], v4 offset:29696
    s_waitcnt vmcnt(1)
    buffer_load_dwordx4 v[60:63], v7, s[20:23], s5 offen sc1
    v_max3_u32 v6, v52, v53, v54
    v_max_u32 v6, v6, v55
    v_cmp_eq_u32 vcc, -1, v6
    s_cbranch_vccnz Lop_retry2
Lop_ok2:
    s_waitcnt lgkmcnt(10)
    v_mfma_f32_16x16x32_bf16 v[28:31], v[120:123], v[52:55], v[28:31]
    v_mfma_f32_16x16x32_bf16 v[32:35], v[124:127], v[52:55], v[32:35]
    ds_read_b128 v[120:123], v12 offset:40960
    v_mfma_f32_16x16x32_bf16 v[88:91], v[128:131], v[52:55], v[88:91]
    ds_read_b128 v[124:127], v12 offset:41984
    v_mfma_f32_16x16x32_bf16 v[92:95], v[132:135], v[52:55], v[92:95]
    ds_read_b128 v[128:131], v14 offset:40960
    v_mfma_f32_16x16x32_bf16 v[96:99], v[136:139], v[52:55], v[96:99]
    ds_read_b128 v[132:135], v14 offset:41984
    ds_read_b128 v[136:139], v4 offset:45056
    s_waitcnt vmcnt(1)
    buffer_load_dwordx4 v[64:67], v2, s[20:23], s6 offen sc1
    v_max3_u32 v6, v56, v57, v58
    v_max_u32 v6, v6, v59
    v_cmp_eq_u32 vcc, -1, v6
    s_cbranch_vccnz Lop_retry3
Lop_ok3:
    s_waitcnt lgkmcnt(10)
    v_mfma_f32_16x16x32_bf16 v[28:31], v[140:143], v[56:59], v[28:31]
    v_mfma_f32_16x16x32_bf16 v[32:35], v[144:147], v[56:59], v[32:35]
    ds_read_b128 v[140:143], v12 offset:46080
    v_mfma_f32_16x16x32_bf16 v[88:91], v[148:151], v[56:59], v[88:91]
    ds_read_b128 v[144:147], v12 offset:47104
    v_mfma_f32_16x16x32_bf16 v[92:95], v[152:155], v[56:59], v[92:95]
    ds_read_b128 v[148:151], v14 offset:46080
    v_mfma_f32_16x16x32_bf16 v[96:99], v[156:159], v[56:59], v[96:99]
    ds_read_b128 v[152:155], v14 offset:47104
    ds_read_b128 v[156:159], v4 offset:50176
    s_waitcnt vmcnt(1)
    buffer_load_dwordx4 v[68:71], v7, s[20:23], s6 offen sc1
    v_max3_u32 v6, v60, v61, v62
    v_max_u32 v6, v6, v63
    v_cmp_eq_u32 vcc, -1, v6
    s_cbranch_vccnz Lop_retry4
Lop_ok4:
    s_waitcnt lgkmcnt(10)
    v_mfma_f32_16x16x32_bf16 v[28:31], v[100:103], v[60:63], v[28:31]
    v_mfma_f32_16x16x32_bf16 v[32:35], v[104:107], v[60:63], v[32:35]
    ds_read_b128 v[100:103], v13 offset:0
    v_mfma_f32_16x16x32_bf16 v[88:91], v[108:111], v[60:63], v[88:91]
    ds_read_b128 v[104:107], v13 offset:1024
    v_mfma_f32_16x16x32_bf16 v[92:95], v[112:115], v[60:63], v[92:95]
    ds_read_b128 v[108:111], v15 offset:0
    v_mfma_f32_16x16x32_bf16 v[96:99], v[116:119], v[60:63], v[96:99]
    ds_read_b128 v[112:115], v15 offset:1024
    ds_read_b128 v[116:119], v5 offset:4096
    s_waitcnt vmcnt(1)
    buffer_load_dwordx4 v[72:75], v2, s[20:23], s7 offen sc1
    v_max3_u32 v6, v64, v65, v66
    v_max_u32 v6, v6, v67
    v_cmp_eq_u32 vcc, -1, v6
    s_cbranch_vccnz Lop_retry5
Lop_ok5:
    s_waitcnt lgkmcnt(10)
    v_mfma_f32_16x16x32_bf16 v[28:31], v[120:123], v[64:67], v[28:31]
    v_mfma_f32_16x16x32_bf16 v[32:35], v[124:127], v[64:67], v[32:35]
    ds_read_b128 v[120:123], v13 offset:5120
    v_mfma_f32_16x16x32_bf16 v[88:91], v[128:131], v[64:67], v[88:91]
    ds_read_b128 v[124:127], v13 offset:6144
    v_mfma_f32_16x16x32_bf16 v[92:95], v[132:135], v[64:67], v[92:95]
    ds_read_b128 v[128:131], v15 offset:5120
    v_mfma_f32_16x16x32_bf16 v[96:99], v[136:139], v[64:67], v[96:99]
    ds_read_b128 v[132:135], v15 offset:6144
    ds_read_b128 v[136:139], v5 offset:9216
    s_waitcnt vmcnt(1)
    buffer_load_dwordx4 v[76:79], v7, s[20:23], s7 offen sc1
    v_max3_u32 v6, v68, v69, v70
    v_max_u32 v6, v6, v71
    v_cmp_eq_u32 vcc, -1, v6
    s_cbranch_vccnz Lop_retry6
Lop_ok6:
    s_waitcnt lgkmcnt(10)
    v_mfma_f32_16x16x32_bf16 v[28:31], v[140:143], v[68:71], v[28:31]
    v_mfma_f32_16x16x32_bf16 v[32:35], v[144:147], v[68:71], v[32:35]
    ds_read_b128 v[140:143], v13 offset:20480
    v_mfma_f32_16x16x32_bf16 v[88:91], v[148:151], v[68:71], v[88:91]
    ds_read_b128 v[144:147], v13 offset:21504
    v_mfma_f32_16x16x32_bf16 v[92:95], v[152:155], v[68:71], v[92:95]
    ds_read_b128 v[148:151], v15 offset:20480
    v_mfma_f32_16x16x32_bf16 v[96:99], v[156:159], v[68:71], v[96:99]
    ds_read_b128 v[152:155], v15 offset:21504
    ds_read_b128 v[156:159], v5 offset:24576
    s_waitcnt vmcnt(1)
    buffer_load_dwordx2 v[80:81], v9, s[20:23], s8 offen sc1
    buffer_load_dwordx2 v[82:83], v9, s[20:23], s40 offen sc1
    v_max3_u32 v6, v72, v73, v74
    v_max_u32 v6, v6, v75
    v_cmp_eq_u32 vcc, -1, v6
    s_cbranch_vccnz Lop_retry7
Lop_ok7:
    s_waitcnt lgkmcnt(10)
    v_mfma_f32_16x16x32_bf16 v[28:31], v[100:103], v[72:75], v[28:31]
    v_mfma_f32_16x16x32_bf16 v[32:35], v[104:107], v[72:75], v[32:35]
    ds_read_b128 v[100:103], v13 offset:25600
    v_mfma_f32_16x16x32_bf16 v[88:91], v[108:111], v[72:75], v[88:91]
    ds_read_b128 v[104:107], v13 offset:26624
    v_mfma_f32_16x16x32_bf16 v[92:95], v[112:115], v[72:75], v[92:95]
    ds_read_b128 v[108:111], v15 offset:25600
    v_mfma_f32_16x16x32_bf16 v[96:99], v[116:119], v[72:75], v[96:99]
    ds_read_b128 v[112:115], v15 offset:26624
    ds_read_b128 v[116:119], v5 offset:29696
    s_waitcnt vmcnt(2)
    buffer_load_dwordx2 v[84:85], v9, s[20:23], s41 offen sc1
    buffer_load_dwordx2 v[86:87], v9, s[20:23], s42 offen sc1
    v_max3_u32 v6, v76, v77, v78
    v_max_u32 v6, v6, v79
    v_cmp_eq_u32 vcc, -1, v6
    s_cbranch_vccnz Lop_retry8
Lop_ok8:
    s_waitcnt lgkmcnt(10)
    v_mfma_f32_16x16x32_bf16 v[28:31], v[120:123], v[76:79], v[28:31]
    v_mfma_f32_16x16x32_bf16 v[32:35], v[124:127], v[76:79], v[32:35]
    v_mfma_f32_16x16x32_bf16 v[88:91], v[128:131], v[76:79], v[88:91]
    v_mfma_f32_16x16x32_bf16 v[92:95], v[132:135], v[76:79], v[92:95]
    v_mfma_f32_16x16x32_bf16 v[96:99], v[136:139], v[76:79], v[96:99]
    s_waitcnt vmcnt(2)
    v_max3_u32 v6, v80, v81, v82
    v_max_u32 v6, v6, v83
    v_cmp_eq_u32 vcc, -1, v6
    s_cbranch_vccnz Lop_retry9
Lop_ok9:
    s_waitcnt lgkmcnt(5)
    v_mfma_f32_16x16x32_bf16 v[28:31], v[140:143], v[80:83], v[28:31]
    v_mfma_f32_16x16x32_bf16 v[32:35], v[144:147], v[80:83], v[32:35]
    v_mfma_f32_16x16x32_bf16 v[88:91], v[148:151], v[80:83], v[88:91]
    v_mfma_f32_16x16x32_bf16 v[92:95], v[152:155], v[80:83], v[92:95]
    v_mfma_f32_16x16x32_bf16 v[96:99], v[156:159], v[80:83], v[96:99]
    s_waitcnt vmcnt(0)
    v_max3_u32 v6, v84, v85, v86
    v_max_u32 v6, v6, v87
    v_cmp_eq_u32 vcc, -1, v6
    s_cbranch_vccnz Lop_retry10
Lop_ok10:
    s_waitcnt lgkmcnt(0)
    v_mfma_f32_16x16x32_bf16 v[28:31], v[100:103], v[84:87], v[28:31]
    v_mfma_f32_16x16x32_bf16 v[32:35], v[104:107], v[84:87], v[32:35]
    v_mfma_f32_16x16x32_bf16 v[88:91], v[108:111], v[84:87], v[88:91]
    v_mfma_f32_16x16x32_bf16 v[92:95], v[112:115], v[84:87], v[92:95]
    v_mfma_f32_16x16x32_bf16 v[96:99], v[116:119], v[84:87], v[96:99]
    s_mul_i32 s36, s10, 3072
    v_add_u32 v12, s36, v1
    s_xor_b32 s36, s10, 4
    s_mul_i32 s36, s36, 3072
    v_add_u32 v13, s36, v1
    s_nop 0
    ds_write_b128 v12, v[88:91] offset:0
    ds_write_b128 v12, v[92:95] offset:1024
    ds_write_b128 v12, v[96:99] offset:2048
    s_waitcnt lgkmcnt(0)
    s_barrier
    ds_read_b128 v[100:103], v13 offset:0
    ds_read_b128 v[104:107], v13 offset:1024
    ds_read_b128 v[108:111], v13 offset:2048
    s_cmp_eq_u32 s60, 0
    s_waitcnt lgkmcnt(1)
    v_pk_add_f32 v[28:29], v[28:29], v[100:101]
    v_pk_add_f32 v[30:31], v[30:31], v[102:103]
    v_pk_add_f32 v[32:33], v[32:33], v[104:105]
    v_pk_add_f32 v[34:35], v[34:35], v[106:107]
    v_cvt_pk_bf16_f32 v16, v28, v29
    v_cvt_pk_bf16_f32 v17, v30, v31
    v_cvt_pk_bf16_f32 v18, v32, v33
    v_cvt_pk_bf16_f32 v19, v34, v35
    s_nop 0
    v_permlane16_swap_b32 v16, v18
    v_permlane16_swap_b32 v17, v19
    v_lshlrev_b32 v28, 16, v16
    v_and_b32 v29, 0xffff0000, v16
    v_lshlrev_b32 v30, 16, v17
    v_and_b32 v31, 0xffff0000, v17
    v_lshlrev_b32 v32, 16, v18
    v_and_b32 v33, 0xffff0000, v18
    v_lshlrev_b32 v34, 16, v19
    v_and_b32 v35, 0xffff0000, v19
    v_pk_add_f32 v[28:29], v[28:29], v[36:37]
    v_pk_add_f32 v[30:31], v[30:31], v[38:39]
    v_pk_add_f32 v[32:33], v[32:33], v[40:41]
    v_pk_add_f32 v[34:35], v[34:35], v[42:43]
    v_cvt_pk_bf16_f32 v16, v28, v29
    v_cvt_pk_bf16_f32 v17, v30, v31
    v_cvt_pk_bf16_f32 v18, v32, v33
    v_cvt_pk_bf16_f32 v19, v34, v35
    buffer_store_dwordx4 v[16:19], v160, s[20:23], s32 offen sc1
    s_nop 0
    v_mfma_f32_16x16x32_bf16 v[48:51], v[22:25], v[16:19], 0
    v_mfma_f32_16x16x32_bf16 v[52:55], v[16:19], v[16:19], 0
    s_cbranch_scc0 Lop_notail
    s_waitcnt lgkmcnt(0)
    v_pk_add_f32 v[96:97], v[96:97], v[108:109]
    v_pk_add_f32 v[98:99], v[98:99], v[110:111]
    v_cvt_pk_bf16_f32 v20, v96, v97
    v_cvt_pk_bf16_f32 v21, v98, v99
    v_lshlrev_b32 v96, 16, v20
    v_and_b32 v97, 0xffff0000, v20
    v_lshlrev_b32 v98, 16, v21
    v_and_b32 v99, 0xffff0000, v21
    v_pk_add_f32 v[96:97], v[96:97], v[44:45]
    v_pk_add_f32 v[98:99], v[98:99], v[46:47]
    v_cvt_pk_bf16_f32 v20, v96, v97
    v_cvt_pk_bf16_f32 v21, v98, v99
    buffer_store_dwordx2 v[20:21], v163, s[20:23], s34 offen sc1
    s_nop 0
    v_mfma_f32_16x16x16_bf16 v[48:51], v[26:27], v[20:21], v[48:51]
    v_mfma_f32_16x16x16_bf16 v[52:55], v[20:21], v[20:21], v[52:55]
Lop_notail:
    s_mov_b32 exec_lo, 0xffff
    s_mov_b32 exec_hi, 0xffff
    s_nop 4
    ds_write_b32 v8, v48 offset:24576
    s_mov_b32 exec_lo, 0x00f0000f
    s_mov_b32 exec_hi, 0xf0000f00
    v_cndmask_b32 v52, v52, v53, s[90:91]
    v_cndmask_b32 v52, v52, v54, s[92:93]
    v_cndmask_b32 v52, v52, v55, s[94:95]
    ds_write_b32 v11, v52 offset:24580
    s_waitcnt lgkmcnt(0)
    s_barrier
    s_branch La_fin
Lop_retry1:
    s_call_b64 s[44:45], Lop_refresh
    s_branch Lop_ok1
Lop_retry2:
    s_call_b64 s[44:45], Lop_refresh
    s_branch Lop_ok2
Lop_retry3:
    s_call_b64 s[44:45], Lop_refresh
    s_branch Lop_ok3
Lop_retry4:
    s_call_b64 s[44:45], Lop_refresh
    s_branch Lop_ok4
Lop_retry5:
    s_call_b64 s[44:45], Lop_refresh
    s_branch Lop_ok5
Lop_retry6:
    s_call_b64 s[44:45], Lop_refresh
    s_branch Lop_ok6
Lop_retry7:
    s_call_b64 s[44:45], Lop_refresh
    s_branch Lop_ok7
Lop_retry8:
    s_call_b64 s[44:45], Lop_refresh
    s_branch Lop_ok8
Lop_retry9:
    s_call_b64 s[44:45], Lop_refresh
    s_branch Lop_ok9
Lop_retry10:
    s_call_b64 s[44:45], Lop_refresh
    s_branch Lop_ok10
Lop_refresh:
    s_mov_b32 s46, 0
    s_waitcnt vmcnt(0)
    v_max3_u32 v6, v48, v49, v50
    v_max_u32 v6, v6, v51
    v_cmp_eq_u32 vcc, -1, v6
    s_cbranch_vccz Lop_rf0
    buffer_load_dwordx4 v[48:51], v2, s[20:23], s4 offen sc0 sc1
    s_mov_b32 s46, 1
Lop_rf0:
    v_max3_u32 v6, v52, v53, v54
    v_max_u32 v6, v6, v55
    v_cmp_eq_u32 vcc, -1, v6
    s_cbranch_vccz Lop_rf1
    buffer_load_dwordx4 v[52:55], v7, s[20:23], s4 offen sc0 sc1
    s_mov_b32 s46, 1
Lop_rf1:
    v_max3_u32 v6, v56, v57, v58
    v_max_u32 v6, v6, v59
    v_cmp_eq_u32 vcc, -1, v6
    s_cbranch_vccz Lop_rf2
    buffer_load_dwordx4 v[56:59], v2, s[20:23], s5 offen sc0 sc1
    s_mov_b32 s46, 1
Lop_rf2:
    v_max3_u32 v6, v60, v61, v62
    v_max_u32 v6, v6, v63
    v_cmp_eq_u32 vcc, -1, v6
    s_cbranch_vccz Lop_rf3
    buffer_load_dwordx4 v[60:63], v7, s[20:23], s5 offen sc0 sc1
    s_mov_b32 s46, 1
Lop_rf3:
    v_max3_u32 v6, v64, v65, v66
    v_max_u32 v6, v6, v67
    v_cmp_eq_u32 vcc, -1, v6
    s_cbranch_vccz Lop_rf4
    buffer_load_dwordx4 v[64:67], v2, s[20:23], s6 offen sc0 sc1
    s_mov_b32 s46, 1
Lop_rf4:
    v_max3_u32 v6, v68, v69, v70
    v_max_u32 v6, v6, v71
    v_cmp_eq_u32 vcc, -1, v6
    s_cbranch_vccz Lop_rf5
    buffer_load_dwordx4 v[68:71], v7, s[20:23], s6 offen sc0 sc1
    s_mov_b32 s46, 1
Lop_rf5:
    v_max3_u32 v6, v72, v73, v74
    v_max_u32 v6, v6, v75
    v_cmp_eq_u32 vcc, -1, v6
    s_cbranch_vccz Lop_rf6
    buffer_load_dwordx4 v[72:75], v2, s[20:23], s7 offen sc0 sc1
    s_mov_b32 s46, 1
Lop_rf6:
    v_max3_u32 v6, v76, v77, v78
    v_max_u32 v6, v6, v79
    v_cmp_eq_u32 vcc, -1, v6
    s_cbranch_vccz Lop_rf7
    buffer_load_dwordx4 v[76:79], v7, s[20:23], s7 offen sc0 sc1
    s_mov_b32 s46, 1
Lop_rf7:
    v_max3_u32 v6, v80, v81, v82
    v_max_u32 v6, v6, v83
    v_cmp_eq_u32 vcc, -1, v6
    s_cbranch_vccz Lop_rf8
    buffer_load_dwordx2 v[80:81], v9, s[20:23], s8 offen sc0 sc1
    buffer_load_dwordx2 v[82:83], v9, s[20:23], s40 offen sc0 sc1
    s_mov_b32 s46, 1
Lop_rf8:
    v_max3_u32 v6, v84, v85, v86
    v_max_u32 v6, v6, v87
    v_cmp_eq_u32 vcc, -1, v6
    s_cbranch_vccz Lop_rf9
    buffer_load_dwordx2 v[84:85], v9, s[20:23], s41 offen sc0 sc1
    buffer_load_dwordx2 v[86:87], v9, s[20:23], s42 offen sc0 sc1
    s_mov_b32 s46, 1
Lop_rf9:
    s_add_u32 s43, s43, 1
    s_cmp_gt_u32 s43, 0x40000
    s_cselect_b32 s46, 0, s46
    s_cmp_eq_u32 s46, 1
    s_cbranch_scc1 Lop_refresh
    s_waitcnt vmcnt(0)
    s_setpc_b64 s[44:45]
Lao_loader:
    s_waitcnt vmcnt(0) lgkmcnt(0)
    s_cmp_eq_u32 s90, 0
    s_cbranch_scc1 Lao_nfl8
    v_mov_b32 v2, s98
    v_lshlrev_b32 v3, 2, v0
    s_mov_b32 exec_lo, -1
    s_mov_b32 exec_hi, 0
    buffer_store_dword v2, v3, s[28:31], s90 offen sc1
    s_mov_b64 exec, -1
Lao_nfl8:
    s_barrier
    v_mov_b32 v2, s98
    v_lshlrev_b32 v3, 2, v0
    s_mov_b32 exec_lo, -1
    s_mov_b32 exec_hi, 0
    buffer_store_dword v2, v3, s[28:31], s91 offen sc1
    s_mov_b64 exec, -1
    v_lshlrev_b32 v1, 4, v0
    s_mul_i32 s79, s74, 102400
    s_add_u32 s79, s79, 0x1d20000
    s_mul_i32 s80, s73, 20480
    s_add_u32 s80, s80, s79
    s_add_u32 s81, s79, 81920
    s_mov_b32 s82, 57792
    s_waitcnt lgkmcnt(0)
    s_cmp_eq_u32 s9, 0
    s_cbranch_scc1 Lao_nf
    s_barrier
Lao_f8:
    s_mov_b32 m0, s82
    s_nop 0
    buffer_load_dwordx4 v1, s[20:23], s80 offen offset:0 sc1 lds
    buffer_load_dwordx4 v1, s[20:23], s80 offen offset:1024 sc1 lds
    buffer_load_dwordx4 v1, s[20:23], s80 offen offset:2048 sc1 lds
    buffer_load_dwordx4 v1, s[20:23], s80 offen offset:3072 sc1 lds
    s_add_u32 s80, s80, 4096
    s_cmp_eq_u32 s80, s81
    s_cselect_b32 s80, s79, s80
    s_add_u32 s82, s82, 4096
    s_cmp_eq_u32 s82, 139712
    s_cselect_b32 s80, s81, s80
    s_cmp_lt_u32 s82, 78272
    s_cbranch_scc1 Lao_f8
    s_barrier
    s_barrier
Lao_nf:
    s_cmp_lg_u32 s3, 0
    s_cbranch_scc1 Lao_l2
    v_lshlrev_b32 v2, 8, v0
    s_lshr_b32 s16, s74, 2
    s_lshl_b32 s16, s16, 7
    s_add_u32 s16, s16, 0x1e58800
    s_barrier
    s_barrier
    s_mov_b64 exec, 0xfffff
    s_mov_b32 s11, s16
    s_mov_b32 s12, 0
    s_mov_b64 s[88:89], exec
Lfw19:
    s_add_u32 s12, s12, 1
    s_and_b32 s99, s12, 7
    s_cbranch_scc1 Lfw19a
    s_mov_b64 exec, s[88:89]
    buffer_load_dword v20, v2, s[28:31], s11 offen sc0 sc1
    s_branch Lfw19b
Lfw19a:
    s_mov_b64 exec, s[88:89]
    buffer_load_dword v20, v2, s[28:31], s11 offen sc1
Lfw19b:
    s_waitcnt vmcnt(0)
    s_mov_b64 exec, s[88:89]
    v_cmp_ne_u32 s[88:89], s98, v20
    s_nop 0
    s_mov_b64 vcc, s[88:89]
    s_cbranch_vccz Lfw19c
    s_sleep 1
    s_cmp_lt_u32 s12, 0x40000
    s_cbranch_scc1 Lfw19
Lfw19c:
    s_mov_b64 exec, -1
    s_branch Lao_lloop
Lao_l2:
    v_lshrrev_b32 v2, 3, v0
    v_and_b32 v3, 7, v0
    v_min_u32 v2, 5, v2
    v_cmp_lt_u32 vcc, 2, v2
    s_nop 1
    v_cndmask_b32 v4, 0, 3, vcc
    v_sub_u32 v4, v2, v4
    v_mov_b32 v5, 80
    v_mov_b32 v6, 160
    v_cndmask_b32 v5, v5, v6, vcc
    s_lshr_b32 s16, s13, 1
    s_mul_i32 s16, s16, 5
    s_and_b32 s17, s13, 1
    s_mul_i32 s17, s17, 3
    v_add_u32 v6, s17, v4
    v_cmp_eq_u32 vcc, 2, v4
    s_nop 1
    v_cndmask_b32 v6, v6, v4, vcc
    v_add_u32 v6, s16, v6
    v_lshlrev_b32 v7, 4, v3
    v_lshl_add_u32 v8, v6, 7, v7
    v_lshl_add_u32 v9, v5, 7, v8
    v_lshlrev_b32 v15, 2, v3
    s_mov_b32 s16, 0x1e09800
    s_mov_b32 s17, 0x1df8900
    s_mov_b32 s12, 0
Lao_qs:
    buffer_load_dword v16, v15, s[20:23], s17 offen sc0 sc1
    buffer_load_dwordx4 v[20:23], v9, s[20:23], s16 offen sc0 sc1
    buffer_load_dwordx4 v[24:27], v8, s[20:23], s16 offen sc0 sc1
    s_add_u32 s12, s12, 1
    s_waitcnt vmcnt(0)
    v_max3_u32 v17, v20, v21, v22
    v_max3_u32 v18, v23, v24, v25
    v_max3_u32 v17, v17, v26, v27
    v_max3_u32 v17, v17, v18, v16
    v_cmp_eq_u32 vcc, -1, v17
    s_cbranch_vccz Lao_qs2
    s_sleep 1
    s_cmp_lt_u32 s12, 0x40000
    s_cbranch_scc1 Lao_qs
Lao_qs2:
    v_and_b32 v16, 2047, v16
    v_sub_u32 v16, 2047, v16
    v_add_u32 v15, 160192, v15
    ds_write_b32 v15, v16
    v_lshl_add_u32 v7, v4, 7, v7
    v_add_u32 v7, 160192, v7
    ds_write_b128 v7, v[24:27] offset:32
    s_lshl_b32 s16, s14, 8
    s_sub_u32 s16, s16, 256
    v_subrev_u32 v16, s16, v16
    v_mul_u32_u24 v2, 8256, v2
    v_lshl_add_u32 v2, v16, 4, v2
    v_cmp_gt_u32 vcc, 0x200, v16
    s_barrier
    s_mov_b64 exec, vcc
    ds_write_b128 v2, v[20:23]
    s_mov_b64 exec, -1
    s_waitcnt lgkmcnt(0)
    s_barrier
    s_barrier
Lao_lloop:
    v_lshlrev_b32 v2, 7, v0
    s_lshl_b32 s11, s97, 15
    s_add_u32 s11, s11, 0x1e18800
Lao_lloop2:
    s_cmp_lg_u32 s82, 119232
    s_cbranch_scc1 Lao_lloop3
    buffer_load_dword v24, v2, s[28:31], s11 offen sc1
    s_add_u32 s11, s11, 8192
    buffer_load_dword v25, v2, s[28:31], s11 offen sc1
    s_add_u32 s11, s11, 8192
    buffer_load_dword v26, v2, s[28:31], s11 offen sc1
    s_add_u32 s11, s11, 8192
    buffer_load_dword v27, v2, s[28:31], s11 offen sc1
    s_add_u32 s11, s11, 8192
Lao_lloop3:
    s_cmp_ge_u32 s82, 160192
    s_cbranch_scc1 Lao_ldone
    s_mov_b32 m0, s82
    s_nop 0
    buffer_load_dwordx4 v1, s[20:23], s80 offen offset:0 sc1 lds
    buffer_load_dwordx4 v1, s[20:23], s80 offen offset:1024 sc1 lds
    buffer_load_dwordx4 v1, s[20:23], s80 offen offset:2048 sc1 lds
    buffer_load_dwordx4 v1, s[20:23], s80 offen offset:3072 sc1 lds
    s_add_u32 s80, s80, 4096
    s_cmp_eq_u32 s80, s81
    s_cselect_b32 s80, s79, s80
    s_add_u32 s82, s82, 4096
    s_cmp_eq_u32 s82, 139712
    s_cselect_b32 s80, s81, s80
    s_waitcnt vmcnt(24)
    s_branch Lao_lloop2
Lao_ldone:
    s_waitcnt vmcnt(0)
    v_xor_b32 v24, s98, v24
    v_xor_b32 v25, s98, v25
    v_xor_b32 v26, s98, v26
    v_xor_b32 v27, s98, v27
    v_or3_b32 v24, v24, v25, v26
    v_or_b32 v24, v24, v27
    v_cmp_ne_u32 vcc, 0, v24
    s_cbranch_vccz Lao_allok
    v_lshlrev_b32 v2, 7, v0
    v_add_u32 v3, 8192, v2
    v_add_u32 v4, 16384, v2
    v_add_u32 v5, 24576, v2
    s_lshl_b32 s11, s97, 15
    s_add_u32 s11, s11, 0x1e18800
    s_mov_b32 s12, 0
    s_mov_b64 s[88:89], exec
    s_mov_b64 s[90:91], exec
    s_mov_b64 s[92:93], exec
    s_mov_b64 s[94:95], exec
Lfw20:
    s_add_u32 s12, s12, 1
    s_and_b32 s99, s12, 7
    s_cbranch_scc1 Lfw20a
    s_mov_b64 exec, s[88:89]
    buffer_load_dword v20, v2, s[28:31], s11 offen sc0 sc1
    s_mov_b64 exec, s[90:91]
    buffer_load_dword v21, v3, s[28:31], s11 offen sc0 sc1
    s_mov_b64 exec, s[92:93]
    buffer_load_dword v22, v4, s[28:31], s11 offen sc0 sc1
    s_mov_b64 exec, s[94:95]
    buffer_load_dword v23, v5, s[28:31], s11 offen sc0 sc1
    s_branch Lfw20b
Lfw20a:
    s_mov_b64 exec, s[88:89]
    buffer_load_dword v20, v2, s[28:31], s11 offen sc1
    s_mov_b64 exec, s[90:91]
    buffer_load_dword v21, v3, s[28:31], s11 offen sc1
    s_mov_b64 exec, s[92:93]
    buffer_load_dword v22, v4, s[28:31], s11 offen sc1
    s_mov_b64 exec, s[94:95]
    buffer_load_dword v23, v5, s[28:31], s11 offen sc1
Lfw20b:
    s_waitcnt vmcnt(0)
    s_mov_b64 exec, s[88:89]
    v_cmp_ne_u32 s[88:89], s98, v20
    s_mov_b64 exec, s[90:91]
    v_cmp_ne_u32 s[90:91], s98, v21
    s_mov_b64 exec, s[92:93]
    v_cmp_ne_u32 s[92:93], s98, v22
    s_mov_b64 exec, s[94:95]
    v_cmp_ne_u32 s[94:95], s98, v23
    s_mov_b64 vcc, s[88:89]
    s_or_b64 vcc, vcc, s[90:91]
    s_or_b64 vcc, vcc, s[92:93]
    s_or_b64 vcc, vcc, s[94:95]
    s_cbranch_vccz Lfw20c
    s_sleep 1
    s_cmp_lt_u32 s12, 0x40000
    s_cbranch_scc1 Lfw20
Lfw20c:
    s_mov_b64 exec, -1
Lao_allok:
    s_barrier
    v_lshlrev_b32 v3, 2, v0
    s_lshl_b32 s16, s72, 10
    s_add_u32 s16, s16, s63
    s_add_u32 s16, s16, 0x1de8000
    v_and_b32 v2, 3, v0
    v_cmp_eq_u32 vcc, 3, v2
    s_barrier
    s_barrier
    ds_read_b32 v8, v3 offset:24576
    ds_read_b32 v9, v3 offset:24832
    ds_read_b32 v10, v3 offset:25088
    ds_read_b32 v11, v3 offset:25344
    ds_read_b32 v12, v3 offset:25600
    ds_read_b32 v13, v3 offset:25856
    ds_read_b32 v14, v3 offset:26112
    ds_read_b32 v15, v3 offset:26368
    s_waitcnt lgkmcnt(0)
    v_add_f32 v8, v8, v12
    v_cndmask_b32 v8, v8, 1.0, vcc
    buffer_atomic_add_f32 v8, v3, s[20:23], s16 offen offset:0
    v_add_f32 v9, v9, v13
    v_cndmask_b32 v9, v9, 1.0, vcc
    buffer_atomic_add_f32 v9, v3, s[20:23], s16 offen offset:256
    v_add_f32 v10, v10, v14
    v_cndmask_b32 v10, v10, 1.0, vcc
    buffer_atomic_add_f32 v10, v3, s[20:23], s16 offen offset:512
    v_add_f32 v11, v11, v15
    v_cndmask_b32 v11, v11, 1.0, vcc
    buffer_atomic_add_f32 v11, v3, s[20:23], s16 offen offset:768
    s_branch La_fin2
Lfix:
    s_load_dwordx2 s[40:41], s[0:1], 8
    s_mov_b32 s42, 0x258000
    s_mov_b32 s43, 0x20000
    s_and_b32 s76, s2, 1
    s_mul_i32 s76, s76, 15
    s_lshr_b32 s77, s2, 1
    s_add_u32 s76, s76, s77
    s_and_b32 s77, s10, 3
    s_lshr_b32 s78, s10, 2
    v_lshrrev_b32 v16, 5, v0
    v_bfe_u32 v17, v0, 3, 2
    v_lshl_add_u32 v16, v16, 3, v17
    v_mul_u32_u24 v16, 3840, v16
    v_and_b32 v17, 7, v0
    v_lshl_add_u32 v20, v17, 4, v16
    s_and_b32 s79, s10, 1
    s_lshl_b32 s79, s79, 4
    s_and_b32 s80, s10, 2
    s_lshl1_add_u32 s79, s80, s79
    s_lshl_b32 s80, s78, 5
    s_add_u32 s79, s79, s80
    s_mul_i32 s79, s79, 3840
    s_lshl_b32 s80, s76, 7
    s_add_u32 s79, s79, s80
    s_lshl_b32 s80, s10, 10
    s_add_u32 s80, s80, 78272
    s_waitcnt lgkmcnt(0)
    s_add_u32 m0, s80, 0
    s_nop 0
    buffer_load_dwordx4 v20, s[40:43], s79 offen lds
    s_add_u32 s79, s79, 245760
    s_add_u32 m0, s80, 8192
    s_nop 0
    buffer_load_dwordx4 v20, s[40:43], s79 offen lds
    s_add_u32 s79, s79, 245760
    s_add_u32 m0, s80, 16384
    s_nop 0
    buffer_load_dwordx4 v20, s[40:43], s79 offen lds
    s_add_u32 s79, s79, 245760
    s_add_u32 m0, s80, 24576
    s_nop 0
    buffer_load_dwordx4 v20, s[40:43], s79 offen lds
    s_add_u32 s79, s79, 245760
    s_add_u32 m0, s80, 32768
    s_nop 0
    buffer_load_dwordx4 v20, s[40:43], s79 offen lds
    s_add_u32 s79, s79, 245760
    s_add_u32 m0, s80, 40960
    s_nop 0
    buffer_load_dwordx4 v20, s[40:43], s79 offen lds
    s_add_u32 s79, s79, 245760
    s_add_u32 m0, s80, 49152
    s_nop 0
    buffer_load_dwordx4 v20, s[40:43], s79 offen lds
    s_add_u32 s79, s79, 245760
    s_add_u32 m0, s80, 57344
    s_nop 0
    buffer_load_dwordx4 v20, s[40:43], s79 offen lds
    s_add_u32 s79, s79, 245760
    s_add_u32 m0, s80, 65536
    s_nop 0
    buffer_load_dwordx4 v20, s[40:43], s79 offen lds
    s_add_u32 s79, s79, 245760
    s_add_u32 m0, s80, 73728
    s_nop 0
    buffer_load_dwordx4 v20, s[40:43], s79 offen lds
    v_lshrrev_b32 v16, 2, v0
    v_lshlrev_b32 v16, 7, v16
    v_and_b32 v17, 3, v0
    v_lshl_add_u32 v16, v17, 3, v16
    s_mul_i32 s79, s77, 20480
    s_lshl_b32 s80, s78, 6
    s_add_u32 s79, s79, s80
    s_add_u32 s79, s79, 78272
    v_add_u32 v16, s79, v16
    v_and_b32 v18, 7, v0
    v_lshrrev_b32 v19, 4, v0
    s_waitcnt vmcnt(0)
    s_barrier
    ds_read_b64_tr_b16 v[68:69], v16 offset:0
    ds_read_b64_tr_b16 v[112:113], v16 offset:32
    ds_read_b64_tr_b16 v[70:71], v16 offset:2048
    ds_read_b64_tr_b16 v[114:115], v16 offset:2080
    ds_read_b64_tr_b16 v[72:73], v16 offset:4096
    ds_read_b64_tr_b16 v[116:117], v16 offset:4128
    ds_read_b64_tr_b16 v[74:75], v16 offset:6144
    ds_read_b64_tr_b16 v[118:119], v16 offset:6176
    ds_read_b64_tr_b16 v[76:77], v16 offset:8192
    ds_read_b64_tr_b16 v[120:121], v16 offset:8224
    ds_read_b64_tr_b16 v[78:79], v16 offset:10240
    ds_read_b64_tr_b16 v[122:123], v16 offset:10272
    ds_read_b64_tr_b16 v[80:81], v16 offset:12288
    ds_read_b64_tr_b16 v[124:125], v16 offset:12320
    ds_read_b64_tr_b16 v[82:83], v16 offset:14336
    ds_read_b64_tr_b16 v[126:127], v16 offset:14368
    ds_read_b64_tr_b16 v[84:85], v16 offset:16384
    ds_read_b64_tr_b16 v[128:129], v16 offset:16416
    ds_read_b64_tr_b16 v[86:87], v16 offset:18432
    ds_read_b64_tr_b16 v[130:131], v16 offset:18464
    v_lshlrev_b32 v17, 7, v19
    v_lshl_add_u32 v17, v18, 4, v17
    s_mul_i32 s79, s77, 2560
    s_add_u32 s79, s79, 0x1df6000
    v_mov_b32 v48, 0x3f803f80
    v_mov_b32 v49, 0x3f803f80
    v_mov_b32 v50, 0x3f803f80
    v_mov_b32 v51, 0x3f803f80
    v_mov_b32 v52, 0x3f803f80
    v_mov_b32 v53, 0x3f803f80
    v_mov_b32 v54, 0x3f803f80
    v_mov_b32 v55, 0x3f803f80
    v_mov_b32 v56, 0x3f803f80
    v_mov_b32 v57, 0x3f803f80
    v_mov_b32 v58, 0x3f803f80
    v_mov_b32 v59, 0x3f803f80
    v_mov_b32 v60, 0x3f803f80
    v_mov_b32 v61, 0x3f803f80
    v_mov_b32 v62, 0x3f803f80
    v_mov_b32 v63, 0x3f803f80
    v_mov_b32 v64, 0x3f803f80
    v_mov_b32 v65, 0x3f803f80
    v_mov_b32 v66, 0x3f803f80
    v_mov_b32 v67, 0x3f803f80
    s_mul_i32 s80, s77, 5120
    v_add_u32 v136, s80, v1
    s_lshl_b32 s81, s78, 11
    v_add_u32 v20, s81, v136
    s_lshl_b32 s80, s10, 10
    v_add_u32 v21, s80, v1
    v_lshrrev_b32 v28, 2, v18
    v_lshlrev_b32 v28, 8, v28
    v_lshl_add_u32 v28, v18, 4, v28
    v_and_b32 v29, 3, v18
    v_lshl_add_u32 v28, v29, 2, v28
    v_lshlrev_b32 v29, 4, v18
    v_lshrrev_b32 v30, 1, v19
    v_lshl_add_u32 v30, v30, 7, v29
    s_lshl2_add_u32 s81, s76, s10
    s_cmp_lt_u32 s81, 40
    s_cselect_b32 s82, 0x3ea52b5c, 1.0
    s_lshl_b32 s81, s81, 8
    s_add_u32 s81, s81, 0x1e09800
    s_mov_b32 exec_lo, 0x00ff00ff
    s_mov_b32 exec_hi, 0x00ff00ff
    s_mov_b32 s80, 0
    buffer_load_dwordx4 v[48:51], v17, s[20:23], s79 offen offset:0 sc1
    buffer_load_dwordx4 v[52:55], v17, s[20:23], s79 offen offset:512 sc1
    buffer_load_dwordx4 v[56:59], v17, s[20:23], s79 offen offset:1024 sc1
    buffer_load_dwordx4 v[60:63], v17, s[20:23], s79 offen offset:1536 sc1
    buffer_load_dwordx4 v[64:67], v17, s[20:23], s79 offen offset:2048 sc1
Ldpx:
    s_mov_b32 s83, 0
    s_waitcnt vmcnt(0)
    v_max3_u32 v31, v48, v49, v50
    v_max_u32 v31, v31, v51
    v_cmp_eq_u32 vcc, -1, v31
    s_cbranch_vccz Ldpx_0
    buffer_load_dwordx4 v[48:51], v17, s[20:23], s79 offen offset:0 sc0 sc1
    s_mov_b32 s83, 1
Ldpx_0:
    v_max3_u32 v31, v52, v53, v54
    v_max_u32 v31, v31, v55
    v_cmp_eq_u32 vcc, -1, v31
    s_cbranch_vccz Ldpx_1
    buffer_load_dwordx4 v[52:55], v17, s[20:23], s79 offen offset:512 sc0 sc1
    s_mov_b32 s83, 1
Ldpx_1:
    v_max3_u32 v31, v56, v57, v58
    v_max_u32 v31, v31, v59
    v_cmp_eq_u32 vcc, -1, v31
    s_cbranch_vccz Ldpx_2
    buffer_load_dwordx4 v[56:59], v17, s[20:23], s79 offen offset:1024 sc0 sc1
    s_mov_b32 s83, 1
Ldpx_2:
    v_max3_u32 v31, v60, v61, v62
    v_max_u32 v31, v31, v63
    v_cmp_eq_u32 vcc, -1, v31
    s_cbranch_vccz Ldpx_3
    buffer_load_dwordx4 v[60:63], v17, s[20:23], s79 offen offset:1536 sc0 sc1
    s_mov_b32 s83, 1
Ldpx_3:
    v_max3_u32 v31, v64, v65, v66
    v_max_u32 v31, v31, v67
    v_cmp_eq_u32 vcc, -1, v31
    s_cbranch_vccz Ldpx_4
    buffer_load_dwordx4 v[64:67], v17, s[20:23], s79 offen offset:2048 sc0 sc1
    s_mov_b32 s83, 1
Ldpx_4:
    s_cmp_eq_u32 s83, 0
    s_cbranch_scc1 Ldpxx
    s_add_u32 s80, s80, 1
    s_cmp_lt_u32 s80, 0x40000
    s_cbranch_scc1 Ldpx
    s_waitcnt vmcnt(0)
Ldpxx:
    s_mov_b64 exec, -1
    s_waitcnt lgkmcnt(0)
    v_mfma_f32_16x16x32_bf16 v[132:135], v[48:51], v[48:51], 0
    v_mfma_f32_16x16x32_bf16 v[88:91], v[68:71], v[48:51], 0
    v_mfma_f32_16x16x32_bf16 v[92:95], v[112:115], v[48:51], 0
    v_mfma_f32_16x16x32_bf16 v[132:135], v[52:55], v[52:55], v[132:135]
    v_mfma_f32_16x16x32_bf16 v[88:91], v[72:75], v[52:55], v[88:91]
    v_mfma_f32_16x16x32_bf16 v[92:95], v[116:119], v[52:55], v[92:95]
    v_mfma_f32_16x16x32_bf16 v[132:135], v[56:59], v[56:59], v[132:135]
    v_mfma_f32_16x16x32_bf16 v[88:91], v[76:79], v[56:59], v[88:91]
    v_mfma_f32_16x16x32_bf16 v[92:95], v[120:123], v[56:59], v[92:95]
    v_mfma_f32_16x16x32_bf16 v[132:135], v[60:63], v[60:63], v[132:135]
    v_mfma_f32_16x16x32_bf16 v[88:91], v[80:83], v[60:63], v[88:91]
    v_mfma_f32_16x16x32_bf16 v[92:95], v[124:127], v[60:63], v[92:95]
    v_mfma_f32_16x16x32_bf16 v[132:135], v[64:67], v[64:67], v[132:135]
    v_mfma_f32_16x16x32_bf16 v[88:91], v[84:87], v[64:67], v[88:91]
    v_mfma_f32_16x16x32_bf16 v[92:95], v[128:131], v[64:67], v[92:95]
    s_nop 5
    ds_write_b128 v136, v[132:135] offset:4096
    ds_write_b128 v20, v[88:91]
    ds_write_b128 v20, v[92:95] offset:1024
    s_waitcnt lgkmcnt(0)
    s_barrier
    s_cmp_gt_u32 s10, 3
    s_cbranch_scc1 Lfix_end
    ds_read_b32 v68, v29 offset:4608
    ds_read_b32 v72, v28 offset:4096
    ds_read_b32 v69, v29 offset:9728
    ds_read_b32 v73, v28 offset:9216
    ds_read_b32 v70, v29 offset:14848
    ds_read_b32 v74, v28 offset:14336
    ds_read_b32 v71, v29 offset:19968
    ds_read_b32 v75, v28 offset:19456
    ds_read_b128 v[48:51], v21 offset:0
    ds_read_b128 v[52:55], v21 offset:5120
    ds_read_b128 v[56:59], v21 offset:10240
    ds_read_b128 v[60:63], v21 offset:15360
    s_waitcnt lgkmcnt(4)
    v_add_f32 v68, v68, v69
    v_add_f32 v70, v70, v71
    v_add_f32 v68, v68, v70
    v_add_f32 v72, v72, v73
    v_add_f32 v74, v74, v75
    v_add_f32 v72, v72, v74
    v_mul_f32 v148, 0x3acccccd, v68
    v_mul_f32 v31, 0x3acccccd, v72
    v_fma_f32 v31, -v148, v148, v31
    v_max_f32 v31, 0, v31
    v_cvt_pk_bf16_f32 v31, v31, v31
    v_and_b32 v31, 0xffff0000, v31
    v_add_f32 v31, 0x3727c5ac, v31
    v_cvt_pk_bf16_f32 v31, v31, v31
    v_and_b32 v31, 0xffff0000, v31
    v_sqrt_f32 v31, v31
    s_nop 0
    v_cvt_pk_bf16_f32 v31, v31, v31
    v_and_b32 v31, 0xffff0000, v31
    v_rcp_f32 v149, v31
    v_cvt_pk_bf16_f32 v148, v148, v148
    v_and_b32 v148, 0xffff0000, v148
    v_mul_f32 v149, s82, v149
    s_waitcnt lgkmcnt(0)
    v_pk_add_f32 v[48:49], v[48:49], v[52:53]
    v_pk_add_f32 v[56:57], v[56:57], v[60:61]
    v_pk_add_f32 v[50:51], v[50:51], v[54:55]
    v_pk_add_f32 v[58:59], v[58:59], v[62:63]
    v_pk_add_f32 v[48:49], v[48:49], v[56:57]
    v_pk_add_f32 v[50:51], v[50:51], v[58:59]
    s_nop 0
    v_mov_b32_dpp v52, v48 row_newbcast:8 row_mask:0xf bank_mask:0xf
    v_mov_b32_dpp v53, v49 row_newbcast:8 row_mask:0xf bank_mask:0xf
    v_mov_b32_dpp v54, v50 row_newbcast:8 row_mask:0xf bank_mask:0xf
    v_mov_b32_dpp v55, v51 row_newbcast:8 row_mask:0xf bank_mask:0xf
    v_fma_f32 v48, -v148, v52, v48
    v_fma_f32 v49, -v148, v53, v49
    v_fma_f32 v50, -v148, v54, v50
    v_fma_f32 v51, -v148, v55, v51
    v_mul_f32 v48, v48, v149
    v_mul_f32 v49, v49, v149
    v_mul_f32 v50, v50, v149
    v_mul_f32 v51, v51, v149
    v_cvt_pk_bf16_f32 v52, v48, v49
    v_cvt_pk_bf16_f32 v53, v50, v51
    v_min_u32 v52, -2, v52
    v_min_u32 v53, -2, v53
    v_mov_b32 v54, v52
    v_mov_b32 v55, v53
    s_nop 0
    v_permlane16_swap_b32 v52, v54
    v_permlane16_swap_b32 v53, v55
    s_mov_b32 exec_lo, 0xff
    s_mov_b32 exec_hi, 0xff
    buffer_store_dwordx4 v[52:55], v30, s[20:23], s81 offen sc1
    s_mov_b64 exec, -1
Lfix_end:
    s_barrier
    s_branch Lfix_done
Latt_exit1:
    v_mfma_f32_32x32x16_bf16 v[112:127], v[148:151], v[132:135], v[112:127]
    s_branch Latt_join
Latt_exact:
    s_mov_b32 s62, 1
    s_mov_b32 exec_lo, 0
    v_mov_b32 v6, 0x3f80
    v_mov_b32 v7, 0
    s_mov_b32 exec_lo, -1
    ds_read_b128 v[80:83], v8 offset:0
    ds_read_b64 v[84:85], v9 offset:0
    s_waitcnt lgkmcnt(0)
    v_mfma_f32_32x32x16_bf16 v[48:63], v[80:83], v[2:5], v[96:111]
    v_mfma_f32_32x32x8_bf16 v[48:63], v[84:85], v[6:7], v[48:63]
    s_nop 11
    v_max_f32 v12, v48, v49
    v_max_f32 v13, v50, v51
    v_max3_f32 v12, v52, v53, v12
    v_max3_f32 v13, v54, v55, v13
    v_max3_f32 v12, v56, v57, v12
    v_max3_f32 v13, v58, v59, v13
    v_max3_f32 v12, v60, v61, v12
    v_max3_f32 v13, v62, v63, v13
    ds_read_b128 v[80:83], v8 offset:512
    ds_read_b64 v[84:85], v9 offset:512
    s_waitcnt lgkmcnt(0)
    v_mfma_f32_32x32x16_bf16 v[48:63], v[80:83], v[2:5], 0
    v_mfma_f32_32x32x8_bf16 v[48:63], v[84:85], v[6:7], v[48:63]
    s_nop 11
    v_max3_f32 v12, v48, v49, v12
    v_max3_f32 v13, v50, v51, v13
    v_max3_f32 v12, v52, v53, v12
    v_max3_f32 v13, v54, v55, v13
    v_max3_f32 v12, v56, v57, v12
    v_max3_f32 v13, v58, v59, v13
    v_max3_f32 v12, v60, v61, v12
    v_max3_f32 v13, v62, v63, v13
    ds_read_b128 v[80:83], v8 offset:1024
    ds_read_b64 v[84:85], v9 offset:1024
    s_waitcnt lgkmcnt(0)
    v_mfma_f32_32x32x16_bf16 v[48:63], v[80:83], v[2:5], 0
    v_mfma_f32_32x32x8_bf16 v[48:63], v[84:85], v[6:7], v[48:63]
    s_nop 11
    v_max3_f32 v12, v48, v49, v12
    v_max3_f32 v13, v50, v51, v13
    v_max3_f32 v12, v52, v53, v12
    v_max3_f32 v13, v54, v55, v13
    v_max3_f32 v12, v56, v57, v12
    v_max3_f32 v13, v58, v59, v13
    v_max3_f32 v12, v60, v61, v12
    v_max3_f32 v13, v62, v63, v13
    ds_read_b128 v[80:83], v8 offset:1536
    ds_read_b64 v[84:85], v9 offset:1536
    s_waitcnt lgkmcnt(0)
    v_mfma_f32_32x32x16_bf16 v[48:63], v[80:83], v[2:5], 0
    v_mfma_f32_32x32x8_bf16 v[48:63], v[84:85], v[6:7], v[48:63]
    s_nop 11
    v_max3_f32 v12, v48, v49, v12
    v_max3_f32 v13, v50, v51, v13
    v_max3_f32 v12, v52, v53, v12
    v_max3_f32 v13, v54, v55, v13
    v_max3_f32 v12, v56, v57, v12
    v_max3_f32 v13, v58, v59, v13
    v_max3_f32 v12, v60, v61, v12
    v_max3_f32 v13, v62, v63, v13
    ds_read_b128 v[80:83], v8 offset:2048
    ds_read_b64 v[84:85], v9 offset:2048
    s_waitcnt lgkmcnt(0)
    v_mfma_f32_32x32x16_bf16 v[48:63], v[80:83], v[2:5], 0
    v_mfma_f32_32x32x8_bf16 v[48:63], v[84:85], v[6:7], v[48:63]
    s_nop 11
    v_max3_f32 v12, v48, v49, v12
    v_max3_f32 v13, v50, v51, v13
    v_max3_f32 v12, v52, v53, v12
    v_max3_f32 v13, v54, v55, v13
    v_max3_f32 v12, v56, v57, v12
    v_max3_f32 v13, v58, v59, v13
    v_max3_f32 v12, v60, v61, v12
    v_max3_f32 v13, v62, v63, v13
    ds_read_b128 v[80:83], v8 offset:2560
    ds_read_b64 v[84:85], v9 offset:2560
    s_waitcnt lgkmcnt(0)
    v_mfma_f32_32x32x16_bf16 v[48:63], v[80:83], v[2:5], 0
    v_mfma_f32_32x32x8_bf16 v[48:63], v[84:85], v[6:7], v[48:63]
    s_nop 11
    v_max3_f32 v12, v48, v49, v12
    v_max3_f32 v13, v50, v51, v13
    v_max3_f32 v12, v52, v53, v12
    v_max3_f32 v13, v54, v55, v13
    v_max3_f32 v12, v56, v57, v12
    v_max3_f32 v13, v58, v59, v13
    v_max3_f32 v12, v60, v61, v12
    v_max3_f32 v13, v62, v63, v13
    ds_read_b128 v[80:83], v8 offset:3072
    ds_read_b64 v[84:85], v9 offset:3072
    s_waitcnt lgkmcnt(0)
    v_mfma_f32_32x32x16_bf16 v[48:63], v[80:83], v[2:5], 0
    v_mfma_f32_32x32x8_bf16 v[48:63], v[84:85], v[6:7], v[48:63]
    s_nop 11
    v_max3_f32 v12, v48, v49, v12
    v_max3_f32 v13, v50, v51, v13
    v_max3_f32 v12, v52, v53, v12
    v_max3_f32 v13, v54, v55, v13
    v_max3_f32 v12, v56, v57, v12
    v_max3_f32 v13, v58, v59, v13
    v_max3_f32 v12, v60, v61, v12
    v_max3_f32 v13, v62, v63, v13
    ds_read_b128 v[80:83], v8 offset:3584
    ds_read_b64 v[84:85], v9 offset:3584
    s_waitcnt lgkmcnt(0)
    v_mfma_f32_32x32x16_bf16 v[48:63], v[80:83], v[2:5], 0
    v_mfma_f32_32x32x8_bf16 v[48:63], v[84:85], v[6:7], v[48:63]
    s_nop 11
    v_max3_f32 v12, v48, v49, v12
    v_max3_f32 v13, v50, v51, v13
    v_max3_f32 v12, v52, v53, v12
    v_max3_f32 v13, v54, v55, v13
    v_max3_f32 v12, v56, v57, v12
    v_max3_f32 v13, v58, v59, v13
    v_max3_f32 v12, v60, v61, v12
    v_max3_f32 v13, v62, v63, v13
    ds_read_b128 v[80:83], v8 offset:4096
    ds_read_b64 v[84:85], v9 offset:4096
    s_waitcnt lgkmcnt(0)
    v_mfma_f32_32x32x16_bf16 v[48:63], v[80:83], v[2:5], v[32:47]
    v_mfma_f32_32x32x8_bf16 v[48:63], v[84:85], v[6:7], v[48:63]
    s_nop 11
    v_max3_f32 v12, v48, v49, v12
    v_max3_f32 v13, v50, v51, v13
    v_max3_f32 v12, v52, v53, v12
    v_max3_f32 v13, v54, v55, v13
    v_max3_f32 v12, v56, v57, v12
    v_max3_f32 v13, v58, v59, v13
    v_max3_f32 v12, v60, v61, v12
    v_max3_f32 v13, v62, v63, v13
    ds_read_b128 v[88:91], v8 offset:0
    ds_read_b64 v[92:93], v9 offset:0
    s_branch Latt_havemax
La_fin:
    s_mov_b64 exec, -1
    s_waitcnt vmcnt(0) lgkmcnt(0)
La_fin2:
    s_barrier
    s_cmp_lg_u32 s10, 8
    s_cbranch_scc1 Lsig21
    s_lshl3_add_u32 s11, s72, s74
    s_lshl_b32 s11, s11, 7
    s_lshl_b32 s12, s97, 15
    s_add_u32 s11, s11, s12
    s_add_u32 s11, s11, 0x1e20800
    v_mov_b32 v2, s98
    v_lshlrev_b32 v3, 2, v0
    s_mov_b32 exec_lo, -1
    s_mov_b32 exec_hi, 0
    buffer_store_dword v2, v3, s[28:31], s11 offen sc1
    s_mov_b64 exec, -1
Lsig21:
    s_add_u32 s97, s97, 1
    s_cmp_lg_u32 s3, 0
    s_cbranch_scc1 Lf_start
    s_mov_b32 s3, 0x1180000
    s_branch Lq_start
Lf_start:
    s_load_dwordx2 s[20:21], s[0:1], 64
    s_mov_b32 s22, 0x280000
    s_mov_b32 s23, 0x20000
    s_cmp_ge_u32 s2, 192
    s_cbranch_scc1 Lfs_bye
    s_mov_b32 s13, s2
    s_mov_b32 s53, 0
    s_mov_b32 s51, 68608
Lfs:
    s_load_dwordx2 s[32:33], s[0:1], 32
    s_mov_b32 s34, 0x500
    s_mov_b32 s35, 0x20000
    s_cmp_eq_u32 s53, 0
    s_mov_b32 s50, 0x1180000
    s_cselect_b32 s50, 0x1480000, s50
    s_cmp_eq_u32 s10, 8
    s_cbranch_scc1 Lfs_w8
    s_lshl_b32 s11, s10, 6
    v_add_u32 v15, s11, v0
    v_lshlrev_b32 v2, 4, v15
    v_mul_u32_u24 v3, 20, v0
    v_lshlrev_b32 v1, 4, v0
    s_add_u32 s44, s51, 0x1de8000
    s_add_u32 s45, s44, 8192
    s_add_u32 s46, s44, 16384
    s_add_u32 s47, s44, 24576
    v_mov_b32 v40, 0
    v_mov_b32 v41, 0
    v_mov_b32 v42, 0
    v_mov_b32 v43, 0
    v_mov_b32 v9, 0
    v_mov_b32 v4, 0x3f803f80
    v_mov_b32 v5, 0x3f803f80
    v_lshrrev_b32 v166, 1, v0
    v_lshlrev_b32 v166, 16, v166
    v_and_b32 v165, 1, v0
    v_lshl_add_u32 v166, v165, 4, v166
    v_and_b32 v10, 7, v0
    v_lshrrev_b32 v13, 4, v0
    s_add_u32 s63, s51, 0x1df8800
    s_cmp_ge_u32 s13, 64
    s_cbranch_scc1 Lfs_elem
    s_cmp_eq_u32 s13, 62
    s_cbranch_scc1 Lfs_fin
    s_cmp_ge_u32 s13, 48
    s_cselect_b32 s54, 1, 0
    s_cmp_ge_u32 s13, 62
    s_cselect_b32 s54, 2, s54
    s_mov_b32 s62, s13
    s_mul_i32 s55, s13, 81920
    s_mul_i32 s56, s10, 10240
    s_add_u32 s55, s55, s56
    s_add_u32 s55, s55, 0x1960000
    s_add_u32 s56, s56, 13312
    s_sub_u32 s14, s13, 48
    s_mul_i32 s14, s14, 3
    s_min_u32 s14, s14, 37
    s_mul_i32 s57, s14, 49152
    s_mul_i32 s12, s10, 6144
    s_add_u32 s57, s57, s12
    s_add_u32 s57, s57, 0x1780000
    s_mul_i32 s58, s10, 18432
    s_add_u32 s58, s58, 13312
    s_waitcnt lgkmcnt(0)
    s_cmp_eq_u32 s54, 1
    s_cbranch_scc1 Lfs_down
    ds_write_b128 v2, v[40:43] offset:0
    ds_write_b32 v9, v9 offset:12288
    buffer_load_dwordx4 v[32:35], v3, s[32:35], 0 offen
    buffer_load_dword v36, v3, s[32:35], 0 offen offset:16
    s_cmp_eq_u32 s54, 1
    s_cbranch_scc1 Lfs_pd0
    s_cmp_eq_u32 s54, 2
    s_cbranch_scc1 Lfs_pn0
    s_add_u32 m0, s56, 0
    s_add_u32 s12, s55, 0
    buffer_load_dwordx4 v1, s[28:31], s12 offen offset:0 sc1 lds
    buffer_load_dwordx4 v1, s[28:31], s12 offen offset:1024 sc1 lds
    s_add_u32 m0, s56, 2048
    s_add_u32 s12, s55, 2048
    buffer_load_dwordx4 v1, s[28:31], s12 offen offset:0 sc1 lds
    buffer_load_dwordx4 v1, s[28:31], s12 offen offset:1024 sc1 lds
    s_waitcnt vmcnt(4)
    s_branch Lfs_px0
Lfs_pd0:
    s_waitcnt vmcnt(0)
    s_branch Lfs_px0
Lfs_pn0:
    s_waitcnt vmcnt(0)
Lfs_px0:
    v_lshlrev_b32 v40, 16, v32
    v_and_b32 v41, 0xffff0000, v32
    v_lshlrev_b32 v42, 16, v33
    v_and_b32 v43, 0xffff0000, v33
    v_lshlrev_b32 v44, 16, v34
    v_and_b32 v45, 0xffff0000, v34
    v_lshlrev_b32 v46, 16, v35
    v_and_b32 v47, 0xffff0000, v35
    v_lshlrev_b32 v48, 16, v36
    v_and_b32 v49, 0xffff0000, v36
    v_pk_add_f32 v[40:41], v[40:41], v[42:43]
    v_pk_add_f32 v[44:45], v[44:45], v[46:47]
    v_pk_add_f32 v[40:41], v[40:41], v[48:49]
    v_pk_add_f32 v[40:41], v[40:41], v[44:45]
    v_add_f32 v32, v40, v41
    s_nop 1
    v_add_f32_dpp v32, v32, v32 row_ror:8 row_mask:0xf bank_mask:0xf
    s_nop 1
    v_add_f32_dpp v32, v32, v32 row_ror:4 row_mask:0xf bank_mask:0xf
    s_nop 1
    v_add_f32_dpp v32, v32, v32 row_ror:2 row_mask:0xf bank_mask:0xf
    s_nop 1
    v_add_f32_dpp v32, v32, v32 row_ror:1 row_mask:0xf bank_mask:0xf
    v_mov_b32 v33, v32
    s_nop 1
    v_permlane16_swap_b32 v32, v33
    v_add_f32 v32, v32, v33
    v_mov_b32 v33, v32
    s_nop 1
    v_permlane32_swap_b32 v32, v33
    v_add_f32 v32, v32, v33
    v_mov_b32 v34, 0x3727c5ac
    v_sub_u32 v36, 2047, v15
    v_sub_u32 v37, 1535, v15
    v_sub_u32 v38, 1023, v15
    v_sub_u32 v39, 511, v15
    s_mov_b32 s15, 0x3acccccd
    s_mov_b32 s16, 0xfffff800
    v_mov_b64 v[140:141], v[4:5]
    v_mov_b64 v[142:143], v[4:5]
    v_mov_b64 v[144:145], v[4:5]
    v_mov_b64 v[146:147], v[4:5]
    v_mov_b64 v[148:149], v[4:5]
    v_mov_b64 v[150:151], v[4:5]
    v_mov_b64 v[152:153], v[4:5]
    v_mov_b64 v[154:155], v[4:5]
    v_mov_b64 v[156:157], v[4:5]
    v_mov_b64 v[158:159], v[4:5]
    v_bfe_u32 v8, v0, 3, 2
    v_lshlrev_b32 v8, 6, v8
    v_and_or_b32 v8, v0, 7, v8
    s_lshl_b32 s11, s10, 3
    v_add_lshl_u32 v8, v8, s11, 7
    s_mov_b32 exec_hi, 0
    s_lshl_b32 s11, s97, 15
    s_add_u32 s11, s11, 0x1e18800
    s_mov_b32 s12, 0
    s_mov_b64 s[88:89], exec
Lfw22:
    s_add_u32 s12, s12, 1
    s_and_b32 s99, s12, 7
    s_cbranch_scc1 Lfw22a
    s_mov_b64 exec, s[88:89]
    buffer_load_dword v20, v8, s[28:31], s11 offen sc0 sc1
    s_branch Lfw22b
Lfw22a:
    s_mov_b64 exec, s[88:89]
    buffer_load_dword v20, v8, s[28:31], s11 offen sc1
Lfw22b:
    s_waitcnt vmcnt(0)
    s_mov_b64 exec, s[88:89]
    v_cmp_ne_u32 s[88:89], s98, v20
    s_nop 0
    s_mov_b64 vcc, s[88:89]
    s_cbranch_vccz Lfw22c
    s_sleep 1
    s_cmp_lt_u32 s12, 0x40000
    s_cbranch_scc1 Lfw22
Lfw22c:
    s_mov_b64 exec, -1
    s_mov_b32 s12, 0
    buffer_load_dwordx4 v[64:67], v2, s[28:31], s44 offen sc1
    buffer_load_dwordx4 v[68:71], v2, s[28:31], s45 offen sc1
    buffer_load_dwordx4 v[72:75], v2, s[28:31], s46 offen sc1
    buffer_load_dwordx4 v[76:79], v2, s[28:31], s47 offen sc1
Lfs_sp:
    s_mov_b32 s18, 0
    s_waitcnt vmcnt(0)
    v_cmp_neq_f32 vcc, 0x41000000, v67
    s_cbranch_vccz Lfs_sp0
    buffer_load_dwordx4 v[64:67], v2, s[28:31], s44 offen sc1
    s_mov_b32 s18, 1
Lfs_sp0:
    v_cmp_neq_f32 vcc, 0x41000000, v71
    s_cbranch_vccz Lfs_sp1
    buffer_load_dwordx4 v[68:71], v2, s[28:31], s45 offen sc1
    s_mov_b32 s18, 1
Lfs_sp1:
    v_cmp_neq_f32 vcc, 0x41000000, v75
    s_cbranch_vccz Lfs_sp2
    buffer_load_dwordx4 v[72:75], v2, s[28:31], s46 offen sc1
    s_mov_b32 s18, 1
Lfs_sp2:
    v_cmp_neq_f32 vcc, 0x41000000, v79
    s_cbranch_vccz Lfs_sp3
    buffer_load_dwordx4 v[76:79], v2, s[28:31], s47 offen sc1
    s_mov_b32 s18, 1
Lfs_sp3:
    s_cmp_eq_u32 s18, 0
    s_cbranch_scc1 Lfs_sq
    s_add_u32 s12, s12, 1
    s_sleep 1
    s_cmp_lt_u32 s12, 0x40000
    s_cbranch_scc1 Lfs_sp
    s_waitcnt vmcnt(0)
Lfs_sq:
    s_cmp_eq_u32 s54, 1
    s_cbranch_scc1 Lfs_pd1
    s_cmp_eq_u32 s54, 2
    s_cbranch_scc1 Lfs_pn1
    s_add_u32 m0, s56, 4096
    s_add_u32 s12, s55, 4096
    buffer_load_dwordx4 v1, s[28:31], s12 offen offset:0 sc1 lds
    buffer_load_dwordx4 v1, s[28:31], s12 offen offset:1024 sc1 lds
    s_add_u32 m0, s56, 6144
    s_add_u32 s12, s55, 6144
    buffer_load_dwordx4 v1, s[28:31], s12 offen offset:0 sc1 lds
    buffer_load_dwordx4 v1, s[28:31], s12 offen offset:1024 sc1 lds
    s_branch Lfs_px1
Lfs_pd1:
Lfs_pn1:
Lfs_px1:
    v_mul_f32 v64, 0x3acccccd, v64
    v_mul_f32 v68, 0x3acccccd, v68
    v_mul_f32 v72, 0x3acccccd, v72
    v_mul_f32 v76, 0x3acccccd, v76
    v_fma_f32 v65, v65, s15, v34
    v_fma_f32 v69, v69, s15, v34
    v_fma_f32 v73, v73, s15, v34
    v_fma_f32 v77, v77, s15, v34
    v_fma_f32 v65, -v64, v64, v65
    v_fma_f32 v69, -v68, v68, v69
    v_fma_f32 v73, -v72, v72, v73
    v_fma_f32 v77, -v76, v76, v77
    v_max_f32 v65, v34, v65
    v_max_f32 v69, v34, v69
    v_max_f32 v73, v34, v73
    v_max_f32 v77, v34, v77
    v_rsq_f32 v65, v65
    v_rsq_f32 v69, v69
    v_rsq_f32 v73, v73
    v_rsq_f32 v77, v77
    v_fma_f32 v28, -v64, v32, v66
    v_fma_f32 v29, -v68, v32, v70
    v_fma_f32 v30, -v72, v32, v74
    v_fma_f32 v31, -v76, v32, v78
    v_mul_f32 v28, v28, v65
    v_mul_f32 v29, v29, v69
    v_mul_f32 v30, v30, v73
    v_mul_f32 v31, v31, v77
    v_ashrrev_i32 v64, 31, v28
    v_ashrrev_i32 v65, 31, v29
    v_ashrrev_i32 v66, 31, v30
    v_ashrrev_i32 v67, 31, v31
    v_or_b32 v64, 0x80000000, v64
    v_or_b32 v65, 0x80000000, v65
    v_or_b32 v66, 0x80000000, v66
    v_or_b32 v67, 0x80000000, v67
    v_xor_b32 v28, v28, v64
    v_xor_b32 v29, v29, v65
    v_xor_b32 v30, v30, v66
    v_xor_b32 v31, v31, v67
    v_and_or_b32 v28, v28, s16, v36
    v_and_or_b32 v29, v29, s16, v37
    v_and_or_b32 v30, v30, s16, v38
    v_and_or_b32 v31, v31, s16, v39
    v_max3_u32 v32, v28, v29, v30
    v_lshrrev_b32 v8, 4, v15
    v_max_u32 v32, v32, v31
    v_lshlrev_b32 v8, 2, v8
    s_nop 0
    v_max_u32_dpp v32, v32, v32 row_ror:8 row_mask:0xf bank_mask:0xf
    s_nop 1
    v_max_u32_dpp v32, v32, v32 row_ror:4 row_mask:0xf bank_mask:0xf
    s_nop 1
    v_max_u32_dpp v32, v32, v32 row_ror:2 row_mask:0xf bank_mask:0xf
    s_nop 1
    v_max_u32_dpp v32, v32, v32 row_ror:1 row_mask:0xf bank_mask:0xf
    ds_write_b32 v8, v32 offset:12416
    v_and_b32 v7, 31, v0
    v_lshlrev_b32 v7, 2, v7
    v_and_b32 v6, 32, v0
    v_lshlrev_b32 v6, 1, v6
    v_mov_b32 v17, 0
    v_mov_b32 v19, 0
    s_cmp_eq_u32 s54, 1
    s_cbranch_scc1 Lfs_pd2
    s_cmp_eq_u32 s54, 2
    s_cbranch_scc1 Lfs_pn2
    s_add_u32 m0, s56, 8192
    s_add_u32 s12, s55, 8192
    buffer_load_dwordx4 v1, s[28:31], s12 offen offset:0 sc1 lds
    buffer_load_dwordx4 v1, s[28:31], s12 offen offset:1024 sc1 lds
    s_branch Lfs_px2
Lfs_pd2:
Lfs_pn2:
Lfs_px2:
    s_waitcnt lgkmcnt(0)
    s_barrier
    ds_read_b32 v16, v7 offset:12416
    ds_read_b128 v[32:35], v6 offset:12416
    ds_read_b128 v[36:39], v6 offset:12432
    ds_read_b128 v[40:43], v6 offset:12448
    ds_read_b128 v[44:47], v6 offset:12464
    s_waitcnt lgkmcnt(2)
    v_cmp_gt_u32 s[64:65], v32, v16
    v_cmp_gt_u32 s[66:67], v33, v16
    v_cmp_gt_u32 s[68:69], v34, v16
    v_cmp_gt_u32 s[70:71], v35, v16
    v_cmp_gt_u32 s[72:73], v36, v16
    v_cmp_gt_u32 s[74:75], v37, v16
    v_cmp_gt_u32 s[76:77], v38, v16
    v_cmp_gt_u32 s[78:79], v39, v16
    v_addc_co_u32 v17, vcc, 0, v17, s[64:65]
    v_addc_co_u32 v19, vcc, 0, v19, s[66:67]
    v_addc_co_u32 v17, vcc, 0, v17, s[68:69]
    v_addc_co_u32 v19, vcc, 0, v19, s[70:71]
    v_addc_co_u32 v17, vcc, 0, v17, s[72:73]
    v_addc_co_u32 v19, vcc, 0, v19, s[74:75]
    v_addc_co_u32 v17, vcc, 0, v17, s[76:77]
    v_addc_co_u32 v19, vcc, 0, v19, s[78:79]
    s_waitcnt lgkmcnt(0)
    v_cmp_gt_u32 s[64:65], v40, v16
    v_cmp_gt_u32 s[66:67], v41, v16
    v_cmp_gt_u32 s[68:69], v42, v16
    v_cmp_gt_u32 s[70:71], v43, v16
    v_cmp_gt_u32 s[72:73], v44, v16
    v_cmp_gt_u32 s[74:75], v45, v16
    v_cmp_gt_u32 s[76:77], v46, v16
    v_cmp_gt_u32 s[78:79], v47, v16
    v_addc_co_u32 v17, vcc, 0, v17, s[64:65]
    v_addc_co_u32 v19, vcc, 0, v19, s[66:67]
    v_addc_co_u32 v17, vcc, 0, v17, s[68:69]
    v_addc_co_u32 v19, vcc, 0, v19, s[70:71]
    v_addc_co_u32 v17, vcc, 0, v17, s[72:73]
    v_addc_co_u32 v19, vcc, 0, v19, s[74:75]
    v_addc_co_u32 v17, vcc, 0, v17, s[76:77]
    v_addc_co_u32 v19, vcc, 0, v19, s[78:79]
    v_add_u32 v17, v17, v19
    v_mov_b32 v19, v17
    s_nop 1
    v_permlane32_swap_b32 v17, v19
    v_add_u32 v17, v17, v19
    v_cmp_eq_u32 vcc, 7, v17
    s_nop 0
    s_ff1_i32_b32 s11, vcc_lo
    v_readlane_b32 s11, v16, s11
    s_nop 1
    v_cmp_le_u32 s[64:65], s11, v28
    v_cmp_le_u32 s[66:67], s11, v29
    v_cmp_le_u32 s[68:69], s11, v30
    v_cmp_le_u32 s[70:71], s11, v31
    s_bcnt1_i32_b64 s80, s[64:65]
    s_bcnt1_i32_b64 s81, s[66:67]
    s_bcnt1_i32_b64 s82, s[68:69]
    s_bcnt1_i32_b64 s83, s[70:71]
    s_mov_b32 s88, 0
    s_add_u32 s89, s88, s80
    s_add_u32 s90, s89, s81
    s_add_u32 s91, s90, s82
    s_add_u32 s92, s91, s83
    v_mov_b32 v33, s92
    s_mov_b64 exec, 1
    ds_add_rtn_u32 v34, v9, v33 offset:12288
    s_mov_b64 exec, -1
    v_mbcnt_lo_u32_b32 v64, s64, 0
    v_mbcnt_hi_u32_b32 v64, s65, v64
    v_add_lshl_u32 v64, v64, s88, 2
    v_mbcnt_lo_u32_b32 v65, s66, 0
    v_mbcnt_hi_u32_b32 v65, s67, v65
    v_add_lshl_u32 v65, v65, s89, 2
    v_mbcnt_lo_u32_b32 v66, s68, 0
    v_mbcnt_hi_u32_b32 v66, s69, v66
    v_add_lshl_u32 v66, v66, s90, 2
    v_mbcnt_lo_u32_b32 v67, s70, 0
    v_mbcnt_hi_u32_b32 v67, s71, v67
    v_add_lshl_u32 v67, v67, s91, 2
    s_waitcnt lgkmcnt(0)
    v_readfirstlane_b32 s95, v34
    s_nop 0
    s_lshl_b32 s95, s95, 2
    s_mov_b64 exec, s[64:65]
    v_add_u32 v64, s95, v64
    ds_write_b32 v64, v28 offset:0
    s_mov_b64 exec, s[66:67]
    v_add_u32 v65, s95, v65
    ds_write_b32 v65, v29 offset:0
    s_mov_b64 exec, s[68:69]
    v_add_u32 v66, s95, v66
    ds_write_b32 v66, v30 offset:0
    s_mov_b64 exec, s[70:71]
    v_add_u32 v67, s95, v67
    ds_write_b32 v67, v31 offset:0
    s_mov_b64 exec, -1
    v_and_b32 v7, 15, v0
    v_lshlrev_b32 v7, 2, v7
    v_and_b32 v6, 48, v0
    s_and_b32 s49, s10, 1
    s_lshl_b32 s49, s49, 2
    v_lshrrev_b32 v3, 4, v0
    v_add_u32 v3, s49, v3
    s_bitcmp1_b32 s10, 1
    s_cselect_b32 s48, 16, 7
    v_lshlrev_b32 v3, s48, v3
    s_cselect_b32 s48, 32, 1280
    s_cselect_b32 s49, 2621440, 0
    s_add_u32 s49, s49, s50
    s_lshl_b32 s17, s10, 5
    s_add_u32 s17, s17, 12544
    s_mov_b32 s12, 0
    s_waitcnt lgkmcnt(0)
    s_barrier
    ds_read_b32 v14, v9 offset:12288
Lfs_rank_outer:
    ds_read_b32 v16, v7 offset:0
    v_mov_b32 v18, v6
    v_mov_b32 v17, 0
    s_mov_b32 s95, 0
Lfs_rank_inner:
    ds_read_b128 v[32:35], v18 offset:0
    v_add_u32 v18, 64, v18
    s_add_u32 s95, s95, 16
    s_waitcnt lgkmcnt(0)
    v_readfirstlane_b32 s94, v14
    v_cmp_gt_u32 s[64:65], v32, v16
    v_cmp_gt_u32 s[66:67], v33, v16
    v_cmp_gt_u32 s[68:69], v34, v16
    v_cmp_gt_u32 s[70:71], v35, v16
    v_addc_co_u32 v17, vcc, 0, v17, s[64:65]
    v_addc_co_u32 v17, vcc, 0, v17, s[66:67]
    v_addc_co_u32 v17, vcc, 0, v17, s[68:69]
    v_addc_co_u32 v17, vcc, 0, v17, s[70:71]
    s_cmp_lt_u32 s95, s94
    s_cbranch_scc1 Lfs_rank_inner
    v_mov_b32 v19, v17
    s_nop 1
    v_permlane16_swap_b32 v17, v19
    v_add_u32 v17, v17, v19
    v_mov_b32 v19, v17
    s_nop 1
    v_permlane32_swap_b32 v17, v19
    v_add_u32 v17, v17, v19
    v_cmp_gt_u32 vcc, 8, v17
    v_lshl_add_u32 v17, v17, 2, s17
    s_and_saveexec_b64 s[18:19], vcc
    ds_write_b32 v17, v16
    s_mov_b64 exec, s[18:19]
    v_add_u32 v7, 64, v7
    s_add_u32 s12, s12, 16
    s_cmp_lt_u32 s12, s94
    s_cbranch_scc1 Lfs_rank_outer
    v_lshl_add_u32 v7, v10, 2, s17
    ds_read_b32 v11, v7
    s_and_b32 s59, s10, 3
    s_lshr_b32 s60, s10, 2
    s_waitcnt lgkmcnt(0)
    v_and_b32 v12, 2047, v11
    v_sub_u32 v12, 2047, v12
    v_lshlrev_b32 v8, 4, v12
    s_cmp_eq_u32 s54, 2
    s_cbranch_scc1 Lfs_none
    v_readlane_b32 s11, v12, s10
    s_mul_i32 s18, s10, 1296
    s_add_u32 m0, s18, 103424
    s_mul_i32 s12, s11, 1280
    s_add_u32 s12, s12, s50
    buffer_load_dwordx4 v1, s[28:31], s12 offen sc1 lds
    s_lshl_b32 s12, s11, 5
    s_add_u32 s12, s12, s50
    s_add_u32 s12, s12, 2621440
    s_add_u32 m0, s18, 104448
    s_mov_b64 exec, 0xffff
    buffer_load_dwordx4 v166, s[28:31], s12 offen sc1 lds
    s_mov_b64 exec, -1
    buffer_load_dwordx2 v[2:3], v8, s[28:31], s44 offen sc1
    v_lshl_add_u32 v6, v0, 3, s56
    s_waitcnt vmcnt(3)
    ds_read_b64_tr_b16 v[100:101], v6 offset:0
    ds_read_b64_tr_b16 v[120:121], v6 offset:5120
    ds_read_b64_tr_b16 v[102:103], v6 offset:512
    ds_read_b64_tr_b16 v[122:123], v6 offset:5632
    ds_read_b64_tr_b16 v[104:105], v6 offset:1024
    ds_read_b64_tr_b16 v[124:125], v6 offset:6144
    ds_read_b64_tr_b16 v[106:107], v6 offset:1536
    ds_read_b64_tr_b16 v[126:127], v6 offset:6656
    ds_read_b64_tr_b16 v[108:109], v6 offset:2048
    ds_read_b64_tr_b16 v[128:129], v6 offset:7168
    ds_read_b64_tr_b16 v[110:111], v6 offset:2560
    ds_read_b64_tr_b16 v[130:131], v6 offset:7680
    ds_read_b64_tr_b16 v[112:113], v6 offset:3072
    ds_read_b64_tr_b16 v[132:133], v6 offset:8192
    ds_read_b64_tr_b16 v[114:115], v6 offset:3584
    ds_read_b64_tr_b16 v[134:135], v6 offset:8704
    ds_read_b64_tr_b16 v[116:117], v6 offset:4096
    ds_read_b64_tr_b16 v[136:137], v6 offset:9216
    ds_read_b64_tr_b16 v[118:119], v6 offset:4608
    ds_read_b64_tr_b16 v[138:139], v6 offset:9728
    v_mul_u32_u24 v6, 1296, v10
    v_lshl_add_u32 v6, v13, 4, v6
    s_mul_i32 s11, s59, 320
    s_add_u32 s11, s11, 103424
    v_add_u32 v6, s11, v6
    v_lshlrev_b32 v7, 6, v10
    v_bfe_u32 v8, v0, 2, 3
    v_lshlrev_b32 v8, 6, v8
    v_and_b32 v9, 3, v0
    v_lshl_add_u32 v8, v9, 3, v8
    v_and_or_b32 v8, v0, 32, v8
    s_lshl_b32 s12, s60, 12
    s_add_u32 s12, s12, 95232
    v_add_u32 v8, s12, v8
    v_lshl_add_u32 v7, v13, 4, v7
    s_lshl_b32 s12, s10, 10
    s_add_u32 s12, s12, 95232
    v_add_u32 v7, s12, v7
    s_waitcnt vmcnt(1)
    s_barrier
    s_mov_b32 exec_lo, 0x00ff00ff
    s_mov_b32 exec_hi, 0x00ff00ff
    ds_read_b128 v[140:143], v6 offset:0
    ds_read_b128 v[144:147], v6 offset:64
    ds_read_b128 v[148:151], v6 offset:128
    ds_read_b128 v[152:155], v6 offset:192
    ds_read_b128 v[156:159], v6 offset:256
    s_mov_b64 exec, -1
    s_waitcnt vmcnt(0)
    v_mul_f32 v4, 0x3acccccd, v2
    v_mul_f32 v14, 0x3acccccd, v3
    v_fma_f32 v14, -v4, v4, v14
    v_max_f32 v14, 0, v14
    v_cvt_pk_bf16_f32 v14, v14, v14
    v_and_b32 v14, 0xffff0000, v14
    v_add_f32 v14, 0x3727c5ac, v14
    v_cvt_pk_bf16_f32 v14, v14, v14
    v_and_b32 v14, 0xffff0000, v14
    v_sqrt_f32 v14, v14
    s_nop 0
    v_cvt_pk_bf16_f32 v14, v14, v14
    v_and_b32 v14, 0xffff0000, v14
    v_rcp_f32 v5, v14
    v_cvt_pk_bf16_f32 v4, v4, v4
    v_and_b32 v4, 0xffff0000, v4
    s_waitcnt lgkmcnt(0)
    v_mfma_f32_16x16x32_bf16 v[80:83], v[100:103], v[140:143], 0
    v_mfma_f32_16x16x32_bf16 v[84:87], v[120:123], v[140:143], 0
    v_mfma_f32_16x16x32_bf16 v[80:83], v[104:107], v[144:147], v[80:83]
    v_mfma_f32_16x16x32_bf16 v[84:87], v[124:127], v[144:147], v[84:87]
    v_mfma_f32_16x16x32_bf16 v[80:83], v[108:111], v[148:151], v[80:83]
    v_mfma_f32_16x16x32_bf16 v[84:87], v[128:131], v[148:151], v[84:87]
    v_mfma_f32_16x16x32_bf16 v[80:83], v[112:115], v[152:155], v[80:83]
    v_mfma_f32_16x16x32_bf16 v[84:87], v[132:135], v[152:155], v[84:87]
    v_mfma_f32_16x16x32_bf16 v[80:83], v[116:119], v[156:159], v[80:83]
    v_mfma_f32_16x16x32_bf16 v[84:87], v[136:139], v[156:159], v[84:87]
    s_nop 6
    v_mov_b32_dpp v100, v80 row_newbcast:8 row_mask:0xf bank_mask:0xf
    v_mov_b32_dpp v101, v81 row_newbcast:8 row_mask:0xf bank_mask:0xf
    v_mov_b32_dpp v102, v82 row_newbcast:8 row_mask:0xf bank_mask:0xf
    v_mov_b32_dpp v103, v83 row_newbcast:8 row_mask:0xf bank_mask:0xf
    v_mov_b32_dpp v104, v84 row_newbcast:8 row_mask:0xf bank_mask:0xf
    v_mov_b32_dpp v105, v85 row_newbcast:8 row_mask:0xf bank_mask:0xf
    v_mov_b32_dpp v106, v86 row_newbcast:8 row_mask:0xf bank_mask:0xf
    v_mov_b32_dpp v107, v87 row_newbcast:8 row_mask:0xf bank_mask:0xf
    v_fma_f32 v80, -v4, v100, v80
    v_fma_f32 v81, -v4, v101, v81
    v_fma_f32 v82, -v4, v102, v82
    v_fma_f32 v83, -v4, v103, v83
    v_fma_f32 v84, -v4, v104, v84
    v_fma_f32 v85, -v4, v105, v85
    v_fma_f32 v86, -v4, v106, v86
    v_fma_f32 v87, -v4, v107, v87
    v_pk_mul_f32 v[80:81], v[80:81], v[4:5] op_sel:[0,1] op_sel_hi:[1,1]
    v_pk_mul_f32 v[82:83], v[82:83], v[4:5] op_sel:[0,1] op_sel_hi:[1,1]
    v_pk_mul_f32 v[84:85], v[84:85], v[4:5] op_sel:[0,1] op_sel_hi:[1,1]
    v_pk_mul_f32 v[86:87], v[86:87], v[4:5] op_sel:[0,1] op_sel_hi:[1,1]
    s_mov_b32 exec_lo, 0x00ff00ff
    s_mov_b32 exec_hi, 0x00ff00ff
    ds_write_b128 v7, v[80:83] offset:0
    ds_write_b128 v7, v[84:87] offset:512
    s_mov_b64 exec, -1
    s_waitcnt lgkmcnt(0)
    s_barrier
    s_cmp_lg_u32 s59, 0
    s_cbranch_scc1 Lfs_gu2
    ds_read_b64 v[140:141], v8 offset:0
    ds_read_b64 v[148:149], v8 offset:512
    ds_read_b64 v[142:143], v8 offset:1024
    ds_read_b64 v[150:151], v8 offset:1536
    ds_read_b64 v[144:145], v8 offset:2048
    ds_read_b64 v[152:153], v8 offset:2560
    ds_read_b64 v[146:147], v8 offset:3072
    ds_read_b64 v[154:155], v8 offset:3584
    v_lshlrev_b32 v7, 2, v0
    s_lshl1_add_u32 s11, s62, s60
    s_lshl_b32 s11, s11, 8
    s_add_u32 s11, s11, 0x1df0000
    s_add_u32 s11, s11, s51
    s_waitcnt lgkmcnt(0)
    v_pk_add_f32 v[140:141], v[140:141], v[142:143]
    v_pk_add_f32 v[144:145], v[144:145], v[146:147]
    v_pk_add_f32 v[148:149], v[148:149], v[150:151]
    v_pk_add_f32 v[152:153], v[152:153], v[154:155]
    v_pk_add_f32 v[80:81], v[140:141], v[144:145]
    v_pk_add_f32 v[84:85], v[148:149], v[152:153]
    v_cvt_pk_bf16_f32 v82, v80, v81
    v_cvt_pk_bf16_f32 v86, v84, v85
    v_lshlrev_b32 v80, 16, v82
    v_and_b32 v81, 0xffff0000, v82
    v_lshlrev_b32 v84, 16, v86
    v_and_b32 v85, 0xffff0000, v86
    v_mul_f32 v82, 0xbfb8aa3b, v80
    v_mul_f32 v83, 0xbfb8aa3b, v81
    v_exp_f32 v82, v82
    v_exp_f32 v83, v83
    v_add_f32 v82, 1.0, v82
    v_add_f32 v83, 1.0, v83
    v_rcp_f32 v82, v82
    v_rcp_f32 v83, v83
    v_mul_f32 v80, v80, v82
    v_mul_f32 v81, v81, v83
    v_cvt_pk_bf16_f32 v82, v80, v81
    v_lshlrev_b32 v80, 16, v82
    v_and_b32 v81, 0xffff0000, v82
    v_mul_f32 v80, v80, v84
    v_mul_f32 v81, v81, v85
    v_cvt_pk_bf16_f32 v82, v80, v81
    v_min_u32 v82, -2, v82
    buffer_store_dword v82, v7, s[28:31], s11 offen sc1
Lfs_gu2:
    s_branch Lfs_fin
Lfs_down:
    s_add_u32 m0, s58, 0
    s_add_u32 s12, s57, 0
    buffer_load_dwordx4 v1, s[28:31], s12 offen offset:0 sc1 lds
    buffer_load_dwordx4 v1, s[28:31], s12 offen offset:1024 sc1 lds
    buffer_load_dwordx4 v1, s[28:31], s12 offen offset:2048 sc1 lds
    s_add_u32 m0, s58, 3072
    s_add_u32 s12, s57, 3072
    buffer_load_dwordx4 v1, s[28:31], s12 offen offset:0 sc1 lds
    buffer_load_dwordx4 v1, s[28:31], s12 offen offset:1024 sc1 lds
    buffer_load_dwordx4 v1, s[28:31], s12 offen offset:2048 sc1 lds
    s_add_u32 m0, s58, 6144
    s_add_u32 s12, s57, 49152
    buffer_load_dwordx4 v1, s[28:31], s12 offen offset:0 sc1 lds
    buffer_load_dwordx4 v1, s[28:31], s12 offen offset:1024 sc1 lds
    buffer_load_dwordx4 v1, s[28:31], s12 offen offset:2048 sc1 lds
    s_add_u32 m0, s58, 9216
    s_add_u32 s12, s57, 52224
    buffer_load_dwordx4 v1, s[28:31], s12 offen offset:0 sc1 lds
    buffer_load_dwordx4 v1, s[28:31], s12 offen offset:1024 sc1 lds
    buffer_load_dwordx4 v1, s[28:31], s12 offen offset:2048 sc1 lds
    s_add_u32 m0, s58, 12288
    s_add_u32 s12, s57, 98304
    buffer_load_dwordx4 v1, s[28:31], s12 offen offset:0 sc1 lds
    buffer_load_dwordx4 v1, s[28:31], s12 offen offset:1024 sc1 lds
    buffer_load_dwordx4 v1, s[28:31], s12 offen offset:2048 sc1 lds
    s_add_u32 m0, s58, 15360
    s_add_u32 s12, s57, 101376
    buffer_load_dwordx4 v1, s[28:31], s12 offen offset:0 sc1 lds
    buffer_load_dwordx4 v1, s[28:31], s12 offen offset:1024 sc1 lds
    buffer_load_dwordx4 v1, s[28:31], s12 offen offset:2048 sc1 lds
    v_lshl_add_u32 v6, v0, 3, s58
    v_lshlrev_b32 v7, 2, v10
    s_waitcnt vmcnt(0)
    ds_read_b64_tr_b16 v[16:17], v6 offset:0
    ds_read_b64_tr_b16 v[18:19], v6 offset:512
    ds_read_b64_tr_b16 v[20:21], v6 offset:1024
    ds_read_b64_tr_b16 v[22:23], v6 offset:1536
    ds_read_b64_tr_b16 v[24:25], v6 offset:2048
    ds_read_b64_tr_b16 v[26:27], v6 offset:2560
    ds_read_b64_tr_b16 v[28:29], v6 offset:3072
    ds_read_b64_tr_b16 v[30:31], v6 offset:3584
    ds_read_b64_tr_b16 v[32:33], v6 offset:4096
    ds_read_b64_tr_b16 v[34:35], v6 offset:4608
    ds_read_b64_tr_b16 v[36:37], v6 offset:5120
    ds_read_b64_tr_b16 v[38:39], v6 offset:5632
    ds_read_b64_tr_b16 v[40:41], v6 offset:6144
    ds_read_b64_tr_b16 v[42:43], v6 offset:6656
    ds_read_b64_tr_b16 v[44:45], v6 offset:7168
    ds_read_b64_tr_b16 v[46:47], v6 offset:7680
    ds_read_b64_tr_b16 v[48:49], v6 offset:8192
    ds_read_b64_tr_b16 v[50:51], v6 offset:8704
    ds_read_b64_tr_b16 v[52:53], v6 offset:9216
    ds_read_b64_tr_b16 v[54:55], v6 offset:9728
    ds_read_b64_tr_b16 v[56:57], v6 offset:10240
    ds_read_b64_tr_b16 v[58:59], v6 offset:10752
    ds_read_b64_tr_b16 v[60:61], v6 offset:11264
    ds_read_b64_tr_b16 v[62:63], v6 offset:11776
    ds_read_b64_tr_b16 v[64:65], v6 offset:12288
    ds_read_b64_tr_b16 v[66:67], v6 offset:12800
    ds_read_b64_tr_b16 v[68:69], v6 offset:13312
    ds_read_b64_tr_b16 v[70:71], v6 offset:13824
    ds_read_b64_tr_b16 v[72:73], v6 offset:14336
    ds_read_b64_tr_b16 v[74:75], v6 offset:14848
    ds_read_b64_tr_b16 v[76:77], v6 offset:15360
    ds_read_b64_tr_b16 v[78:79], v6 offset:15872
    ds_read_b64_tr_b16 v[80:81], v6 offset:16384
    ds_read_b64_tr_b16 v[82:83], v6 offset:16896
    ds_read_b64_tr_b16 v[84:85], v6 offset:17408
    ds_read_b64_tr_b16 v[86:87], v6 offset:17920
    v_mov_b32 v14, 0
    s_cmp_gt_u32 s10, 2
    s_cbranch_scc1 Lfs_down2
    s_mov_b32 s15, 0
Lfs_seld:
    buffer_load_dword v11, v7, s[28:31], s63 offen sc1
    s_waitcnt vmcnt(0)
    v_cmp_eq_u32 vcc, -1, v11
    s_add_u32 s15, s15, 1
    s_cbranch_vccz Lfs_seldx
    s_sleep 1
    s_cmp_lt_u32 s15, 0x40000
    s_cbranch_scc1 Lfs_seld
Lfs_seldx:
    v_and_b32 v12, 2047, v11
    v_sub_u32 v12, 2047, v12
    v_lshlrev_b32 v8, 4, v12
    s_min_u32 s61, s10, 2
    s_add_u32 s61, s61, s14
    s_lshl_b32 s11, s61, 5
    s_mov_b32 s16, s11
    s_add_u32 s11, s11, s50
    v_mul_u32_u24 v14, 1280, v12
    v_lshl_add_u32 v14, v13, 3, v14
    buffer_load_dwordx2 v[2:3], v8, s[28:31], s44 offen sc1
    v_lshlrev_b32 v7, 5, v12
    v_lshl_add_u32 v7, v13, 3, v7
    s_lshl_b32 s12, s61, 16
    s_add_u32 s12, s12, s50
    s_add_u32 s12, s12, 0x80000
    s_cmp_ge_u32 s61, 32
    s_cselect_b32 s11, s12, s11
    s_cselect_b64 vcc, -1, 0
    v_cndmask_b32 v7, v14, v7, vcc
    buffer_load_dwordx2 v[128:129], v7, s[28:31], s11 offen sc1
    v_and_b32 v8, 0xfffff800, v11
    v_ashrrev_i32 v9, 31, v8
    v_not_b32 v9, v9
    v_or_b32 v9, 0x80000000, v9
    v_xor_b32 v8, v8, v9
    v_cvt_pk_bf16_f32 v8, v8, v8
    v_and_b32 v8, 0xffff0000, v8
    v_mul_f32 v8, 0xbfb8aa3b, v8
    v_exp_f32 v8, v8
    s_nop 0
    v_add_f32 v8, 1.0, v8
    v_rcp_f32 v8, v8
    s_nop 0
    v_cvt_pk_bf16_f32 v136, v8, v8
    v_and_b32 v136, 0xffff0000, v136
    s_waitcnt vmcnt(0)
    v_mul_f32 v4, 0x3acccccd, v2
    v_mul_f32 v7, 0x3acccccd, v3
    v_fma_f32 v7, -v4, v4, v7
    v_max_f32 v7, 0, v7
    v_cvt_pk_bf16_f32 v7, v7, v7
    v_and_b32 v7, 0xffff0000, v7
    v_add_f32 v7, 0x3727c5ac, v7
    v_cvt_pk_bf16_f32 v7, v7, v7
    v_and_b32 v7, 0xffff0000, v7
    v_sqrt_f32 v7, v7
    s_nop 0
    v_cvt_pk_bf16_f32 v7, v7, v7
    v_and_b32 v7, 0xffff0000, v7
    v_rcp_f32 v5, v7
    v_cvt_pk_bf16_f32 v4, v4, v4
    v_and_b32 v4, 0xffff0000, v4
    v_lshlrev_b32 v124, 16, v128
    v_and_b32 v125, 0xffff0000, v128
    v_pk_add_f32 v[134:135], v[124:125], v[4:5] op_sel_hi:[1,0] neg_lo:[0,1] neg_hi:[0,1]
    s_nop 0
    v_cvt_pk_bf16_f32 v132, v134, v135
    v_lshlrev_b32 v134, 16, v132
    v_and_b32 v135, 0xffff0000, v132
    v_pk_mul_f32 v[134:135], v[134:135], v[4:5] op_sel:[0,1] op_sel_hi:[1,1]
    s_nop 0
    v_cvt_pk_bf16_f32 v132, v134, v135
    v_mov_b32 v138, v132
    v_lshlrev_b32 v126, 16, v129
    v_and_b32 v127, 0xffff0000, v129
    v_pk_add_f32 v[134:135], v[126:127], v[4:5] op_sel_hi:[1,0] neg_lo:[0,1] neg_hi:[0,1]
    s_nop 0
    v_cvt_pk_bf16_f32 v132, v134, v135
    v_lshlrev_b32 v134, 16, v132
    v_and_b32 v135, 0xffff0000, v132
    v_pk_mul_f32 v[134:135], v[134:135], v[4:5] op_sel:[0,1] op_sel_hi:[1,1]
    s_nop 0
    v_cvt_pk_bf16_f32 v132, v134, v135
    v_mov_b32 v139, v132
    s_branch Lfs_down2
Lfs_none:
    s_cmp_lg_u32 s10, 0
    s_cbranch_scc1 Lfs_fin
    v_bfe_u32 v7, v0, 3, 2
    v_lshlrev_b32 v7, 7, v7
    v_lshl_add_u32 v7, v10, 2, v7
    s_mov_b64 exec, 0xffffff
    buffer_store_dword v11, v7, s[28:31], s63 offen sc1
    s_branch Lfs_fin
Lfs_elem:
    s_cmp_gt_u32 s10, 3
    s_cbranch_scc1 Lfs_fin
    s_waitcnt lgkmcnt(0)
    s_mov_b32 s15, 0
Lfs_sele:
    buffer_load_dwordx4 v[48:51], v9, s[28:31], s63 offen offset:128 sc1
    buffer_load_dwordx4 v[52:55], v9, s[28:31], s63 offen offset:144 sc1
    s_waitcnt vmcnt(0)
    v_max3_u32 v8, v48, v49, v50
    v_max3_u32 v8, v8, v51, v52
    v_max3_u32 v8, v8, v53, v54
    v_max_u32 v8, v8, v55
    v_cmp_eq_u32 vcc, -1, v8
    s_add_u32 s15, s15, 1
    s_cbranch_vccz Lfs_selex
    s_sleep 4
    s_cmp_lt_u32 s15, 0x40000
    s_cbranch_scc1 Lfs_sele
Lfs_selex:
    s_sub_u32 s11, s13, 64
    s_mul_i32 s12, s11, 20480
    s_mov_b32 s18, s12
    s_add_u32 s12, s12, s50
    v_lshrrev_b32 v40, 4, v15
    v_mul_u32_u24 v41, 1280, v40
    v_and_b32 v42, 15, v15
    v_lshl_add_u32 v41, v42, 4, v41
    buffer_load_dwordx4 v[60:63], v41, s[28:31], s12 offen offset:0 sc1
    buffer_load_dwordx4 v[64:67], v41, s[28:31], s12 offen offset:256 sc1
    buffer_load_dwordx4 v[68:71], v41, s[28:31], s12 offen offset:512 sc1
    buffer_load_dwordx4 v[72:75], v41, s[28:31], s12 offen offset:768 sc1
    v_lshrrev_b32 v43, 1, v42
    v_lshlrev_b32 v43, 16, v43
    v_lshl_add_u32 v43, v40, 5, v43
    v_and_b32 v42, 1, v42
    v_lshl_add_u32 v43, v42, 4, v43
    s_lshl_b32 s12, s11, 9
    s_add_u32 s12, s12, s50
    s_add_u32 s12, s12, 2621440
    buffer_load_dwordx4 v[76:79], v43, s[28:31], s12 offen sc1
    s_lshl_b32 s19, s11, 4
    v_add_u32 v40, s19, v40
    v_lshlrev_b32 v42, 4, v40
    buffer_load_dwordx2 v[44:45], v42, s[28:31], s44 offen sc1
    v_sub_u32 v40, 2047, v40
    s_waitcnt vmcnt(0) lgkmcnt(0)
    v_mul_f32 v46, 0x3acccccd, v44
    v_mul_f32 v43, 0x3acccccd, v45
    v_fma_f32 v43, -v46, v46, v43
    v_max_f32 v43, 0, v43
    v_cvt_pk_bf16_f32 v43, v43, v43
    v_and_b32 v43, 0xffff0000, v43
    v_add_f32 v43, 0x3727c5ac, v43
    v_cvt_pk_bf16_f32 v43, v43, v43
    v_and_b32 v43, 0xffff0000, v43
    v_sqrt_f32 v43, v43
    s_nop 0
    v_cvt_pk_bf16_f32 v43, v43, v43
    v_and_b32 v43, 0xffff0000, v43
    v_rcp_f32 v47, v43
    v_cvt_pk_bf16_f32 v46, v46, v46
    v_and_b32 v46, 0xffff0000, v46
    v_and_b32 v48, 2047, v48
    v_cmp_ne_u32 vcc, v48, v40
    s_nop 0
    s_and_b64 exec, exec, vcc
    v_and_b32 v49, 2047, v49
    v_cmp_ne_u32 vcc, v49, v40
    s_nop 0
    s_and_b64 exec, exec, vcc
    v_and_b32 v50, 2047, v50
    v_cmp_ne_u32 vcc, v50, v40
    s_nop 0
    s_and_b64 exec, exec, vcc
    v_and_b32 v51, 2047, v51
    v_cmp_ne_u32 vcc, v51, v40
    s_nop 0
    s_and_b64 exec, exec, vcc
    v_and_b32 v52, 2047, v52
    v_cmp_ne_u32 vcc, v52, v40
    s_nop 0
    s_and_b64 exec, exec, vcc
    v_and_b32 v53, 2047, v53
    v_cmp_ne_u32 vcc, v53, v40
    s_nop 0
    s_and_b64 exec, exec, vcc
    v_and_b32 v54, 2047, v54
    v_cmp_ne_u32 vcc, v54, v40
    s_nop 0
    s_and_b64 exec, exec, vcc
    v_and_b32 v55, 2047, v55
    v_cmp_ne_u32 vcc, v55, v40
    s_nop 0
    s_and_b64 exec, exec, vcc
    s_cbranch_execz Lfs_eskip
    v_lshlrev_b32 v52, 16, v60
    v_and_b32 v53, 0xffff0000, v60
    v_lshlrev_b32 v58, 16, v61
    v_and_b32 v59, 0xffff0000, v61
    v_pk_add_f32 v[50:51], v[52:53], v[46:47] op_sel_hi:[1,0] neg_lo:[0,1] neg_hi:[0,1]
    v_pk_add_f32 v[56:57], v[58:59], v[46:47] op_sel_hi:[1,0] neg_lo:[0,1] neg_hi:[0,1]
    v_cvt_pk_bf16_f32 v48, v50, v51
    v_cvt_pk_bf16_f32 v54, v56, v57
    v_lshlrev_b32 v50, 16, v48
    v_and_b32 v51, 0xffff0000, v48
    v_lshlrev_b32 v56, 16, v54
    v_and_b32 v57, 0xffff0000, v54
    v_pk_mul_f32 v[50:51], v[50:51], v[46:47] op_sel:[0,1] op_sel_hi:[1,1]
    v_pk_mul_f32 v[56:57], v[56:57], v[46:47] op_sel:[0,1] op_sel_hi:[1,1]
    v_cvt_pk_bf16_f32 v48, v50, v51
    v_cvt_pk_bf16_f32 v54, v56, v57
    v_lshlrev_b32 v50, 16, v48
    v_and_b32 v51, 0xffff0000, v48
    v_lshlrev_b32 v56, 16, v54
    v_and_b32 v57, 0xffff0000, v54
    v_pk_add_f32 v[50:51], v[50:51], v[52:53]
    v_pk_add_f32 v[56:57], v[56:57], v[58:59]
    v_cvt_pk_bf16_f32 v60, v50, v51
    v_cvt_pk_bf16_f32 v61, v56, v57
    v_lshlrev_b32 v52, 16, v62
    v_and_b32 v53, 0xffff0000, v62
    v_lshlrev_b32 v58, 16, v63
    v_and_b32 v59, 0xffff0000, v63
    v_pk_add_f32 v[50:51], v[52:53], v[46:47] op_sel_hi:[1,0] neg_lo:[0,1] neg_hi:[0,1]
    v_pk_add_f32 v[56:57], v[58:59], v[46:47] op_sel_hi:[1,0] neg_lo:[0,1] neg_hi:[0,1]
    v_cvt_pk_bf16_f32 v48, v50, v51
    v_cvt_pk_bf16_f32 v54, v56, v57
    v_lshlrev_b32 v50, 16, v48
    v_and_b32 v51, 0xffff0000, v48
    v_lshlrev_b32 v56, 16, v54
    v_and_b32 v57, 0xffff0000, v54
    v_pk_mul_f32 v[50:51], v[50:51], v[46:47] op_sel:[0,1] op_sel_hi:[1,1]
    v_pk_mul_f32 v[56:57], v[56:57], v[46:47] op_sel:[0,1] op_sel_hi:[1,1]
    v_cvt_pk_bf16_f32 v48, v50, v51
    v_cvt_pk_bf16_f32 v54, v56, v57
    v_lshlrev_b32 v50, 16, v48
    v_and_b32 v51, 0xffff0000, v48
    v_lshlrev_b32 v56, 16, v54
    v_and_b32 v57, 0xffff0000, v54
    v_pk_add_f32 v[50:51], v[50:51], v[52:53]
    v_pk_add_f32 v[56:57], v[56:57], v[58:59]
    v_cvt_pk_bf16_f32 v62, v50, v51
    v_cvt_pk_bf16_f32 v63, v56, v57
    buffer_store_dwordx4 v[60:63], v41, s[20:23], s18 offen offset:0 sc1
    v_lshlrev_b32 v52, 16, v64
    v_and_b32 v53, 0xffff0000, v64
    v_lshlrev_b32 v58, 16, v65
    v_and_b32 v59, 0xffff0000, v65
    v_pk_add_f32 v[50:51], v[52:53], v[46:47] op_sel_hi:[1,0] neg_lo:[0,1] neg_hi:[0,1]
    v_pk_add_f32 v[56:57], v[58:59], v[46:47] op_sel_hi:[1,0] neg_lo:[0,1] neg_hi:[0,1]
    v_cvt_pk_bf16_f32 v48, v50, v51
    v_cvt_pk_bf16_f32 v54, v56, v57
    v_lshlrev_b32 v50, 16, v48
    v_and_b32 v51, 0xffff0000, v48
    v_lshlrev_b32 v56, 16, v54
    v_and_b32 v57, 0xffff0000, v54
    v_pk_mul_f32 v[50:51], v[50:51], v[46:47] op_sel:[0,1] op_sel_hi:[1,1]
    v_pk_mul_f32 v[56:57], v[56:57], v[46:47] op_sel:[0,1] op_sel_hi:[1,1]
    v_cvt_pk_bf16_f32 v48, v50, v51
    v_cvt_pk_bf16_f32 v54, v56, v57
    v_lshlrev_b32 v50, 16, v48
    v_and_b32 v51, 0xffff0000, v48
    v_lshlrev_b32 v56, 16, v54
    v_and_b32 v57, 0xffff0000, v54
    v_pk_add_f32 v[50:51], v[50:51], v[52:53]
    v_pk_add_f32 v[56:57], v[56:57], v[58:59]
    v_cvt_pk_bf16_f32 v64, v50, v51
    v_cvt_pk_bf16_f32 v65, v56, v57
    v_lshlrev_b32 v52, 16, v66
    v_and_b32 v53, 0xffff0000, v66
    v_lshlrev_b32 v58, 16, v67
    v_and_b32 v59, 0xffff0000, v67
    v_pk_add_f32 v[50:51], v[52:53], v[46:47] op_sel_hi:[1,0] neg_lo:[0,1] neg_hi:[0,1]
    v_pk_add_f32 v[56:57], v[58:59], v[46:47] op_sel_hi:[1,0] neg_lo:[0,1] neg_hi:[0,1]
    v_cvt_pk_bf16_f32 v48, v50, v51
    v_cvt_pk_bf16_f32 v54, v56, v57
    v_lshlrev_b32 v50, 16, v48
    v_and_b32 v51, 0xffff0000, v48
    v_lshlrev_b32 v56, 16, v54
    v_and_b32 v57, 0xffff0000, v54
    v_pk_mul_f32 v[50:51], v[50:51], v[46:47] op_sel:[0,1] op_sel_hi:[1,1]
    v_pk_mul_f32 v[56:57], v[56:57], v[46:47] op_sel:[0,1] op_sel_hi:[1,1]
    v_cvt_pk_bf16_f32 v48, v50, v51
    v_cvt_pk_bf16_f32 v54, v56, v57
    v_lshlrev_b32 v50, 16, v48
    v_and_b32 v51, 0xffff0000, v48
    v_lshlrev_b32 v56, 16, v54
    v_and_b32 v57, 0xffff0000, v54
    v_pk_add_f32 v[50:51], v[50:51], v[52:53]
    v_pk_add_f32 v[56:57], v[56:57], v[58:59]
    v_cvt_pk_bf16_f32 v66, v50, v51
    v_cvt_pk_bf16_f32 v67, v56, v57
    buffer_store_dwordx4 v[64:67], v41, s[20:23], s18 offen offset:256 sc1
    v_lshlrev_b32 v52, 16, v68
    v_and_b32 v53, 0xffff0000, v68
    v_lshlrev_b32 v58, 16, v69
    v_and_b32 v59, 0xffff0000, v69
    v_pk_add_f32 v[50:51], v[52:53], v[46:47] op_sel_hi:[1,0] neg_lo:[0,1] neg_hi:[0,1]
    v_pk_add_f32 v[56:57], v[58:59], v[46:47] op_sel_hi:[1,0] neg_lo:[0,1] neg_hi:[0,1]
    v_cvt_pk_bf16_f32 v48, v50, v51
    v_cvt_pk_bf16_f32 v54, v56, v57
    v_lshlrev_b32 v50, 16, v48
    v_and_b32 v51, 0xffff0000, v48
    v_lshlrev_b32 v56, 16, v54
    v_and_b32 v57, 0xffff0000, v54
    v_pk_mul_f32 v[50:51], v[50:51], v[46:47] op_sel:[0,1] op_sel_hi:[1,1]
    v_pk_mul_f32 v[56:57], v[56:57], v[46:47] op_sel:[0,1] op_sel_hi:[1,1]
    v_cvt_pk_bf16_f32 v48, v50, v51
    v_cvt_pk_bf16_f32 v54, v56, v57
    v_lshlrev_b32 v50, 16, v48
    v_and_b32 v51, 0xffff0000, v48
    v_lshlrev_b32 v56, 16, v54
    v_and_b32 v57, 0xffff0000, v54
    v_pk_add_f32 v[50:51], v[50:51], v[52:53]
    v_pk_add_f32 v[56:57], v[56:57], v[58:59]
    v_cvt_pk_bf16_f32 v68, v50, v51
    v_cvt_pk_bf16_f32 v69, v56, v57
    v_lshlrev_b32 v52, 16, v70
    v_and_b32 v53, 0xffff0000, v70
    v_lshlrev_b32 v58, 16, v71
    v_and_b32 v59, 0xffff0000, v71
    v_pk_add_f32 v[50:51], v[52:53], v[46:47] op_sel_hi:[1,0] neg_lo:[0,1] neg_hi:[0,1]
    v_pk_add_f32 v[56:57], v[58:59], v[46:47] op_sel_hi:[1,0] neg_lo:[0,1] neg_hi:[0,1]
    v_cvt_pk_bf16_f32 v48, v50, v51
    v_cvt_pk_bf16_f32 v54, v56, v57
    v_lshlrev_b32 v50, 16, v48
    v_and_b32 v51, 0xffff0000, v48
    v_lshlrev_b32 v56, 16, v54
    v_and_b32 v57, 0xffff0000, v54
    v_pk_mul_f32 v[50:51], v[50:51], v[46:47] op_sel:[0,1] op_sel_hi:[1,1]
    v_pk_mul_f32 v[56:57], v[56:57], v[46:47] op_sel:[0,1] op_sel_hi:[1,1]
    v_cvt_pk_bf16_f32 v48, v50, v51
    v_cvt_pk_bf16_f32 v54, v56, v57
    v_lshlrev_b32 v50, 16, v48
    v_and_b32 v51, 0xffff0000, v48
    v_lshlrev_b32 v56, 16, v54
    v_and_b32 v57, 0xffff0000, v54
    v_pk_add_f32 v[50:51], v[50:51], v[52:53]
    v_pk_add_f32 v[56:57], v[56:57], v[58:59]
    v_cvt_pk_bf16_f32 v70, v50, v51
    v_cvt_pk_bf16_f32 v71, v56, v57
    buffer_store_dwordx4 v[68:71], v41, s[20:23], s18 offen offset:512 sc1
    v_lshlrev_b32 v52, 16, v72
    v_and_b32 v53, 0xffff0000, v72
    v_lshlrev_b32 v58, 16, v73
    v_and_b32 v59, 0xffff0000, v73
    v_pk_add_f32 v[50:51], v[52:53], v[46:47] op_sel_hi:[1,0] neg_lo:[0,1] neg_hi:[0,1]
    v_pk_add_f32 v[56:57], v[58:59], v[46:47] op_sel_hi:[1,0] neg_lo:[0,1] neg_hi:[0,1]
    v_cvt_pk_bf16_f32 v48, v50, v51
    v_cvt_pk_bf16_f32 v54, v56, v57
    v_lshlrev_b32 v50, 16, v48
    v_and_b32 v51, 0xffff0000, v48
    v_lshlrev_b32 v56, 16, v54
    v_and_b32 v57, 0xffff0000, v54
    v_pk_mul_f32 v[50:51], v[50:51], v[46:47] op_sel:[0,1] op_sel_hi:[1,1]
    v_pk_mul_f32 v[56:57], v[56:57], v[46:47] op_sel:[0,1] op_sel_hi:[1,1]
    v_cvt_pk_bf16_f32 v48, v50, v51
    v_cvt_pk_bf16_f32 v54, v56, v57
    v_lshlrev_b32 v50, 16, v48
    v_and_b32 v51, 0xffff0000, v48
    v_lshlrev_b32 v56, 16, v54
    v_and_b32 v57, 0xffff0000, v54
    v_pk_add_f32 v[50:51], v[50:51], v[52:53]
    v_pk_add_f32 v[56:57], v[56:57], v[58:59]
    v_cvt_pk_bf16_f32 v72, v50, v51
    v_cvt_pk_bf16_f32 v73, v56, v57
    v_lshlrev_b32 v52, 16, v74
    v_and_b32 v53, 0xffff0000, v74
    v_lshlrev_b32 v58, 16, v75
    v_and_b32 v59, 0xffff0000, v75
    v_pk_add_f32 v[50:51], v[52:53], v[46:47] op_sel_hi:[1,0] neg_lo:[0,1] neg_hi:[0,1]
    v_pk_add_f32 v[56:57], v[58:59], v[46:47] op_sel_hi:[1,0] neg_lo:[0,1] neg_hi:[0,1]
    v_cvt_pk_bf16_f32 v48, v50, v51
    v_cvt_pk_bf16_f32 v54, v56, v57
    v_lshlrev_b32 v50, 16, v48
    v_and_b32 v51, 0xffff0000, v48
    v_lshlrev_b32 v56, 16, v54
    v_and_b32 v57, 0xffff0000, v54
    v_pk_mul_f32 v[50:51], v[50:51], v[46:47] op_sel:[0,1] op_sel_hi:[1,1]
    v_pk_mul_f32 v[56:57], v[56:57], v[46:47] op_sel:[0,1] op_sel_hi:[1,1]
    v_cvt_pk_bf16_f32 v48, v50, v51
    v_cvt_pk_bf16_f32 v54, v56, v57
    v_lshlrev_b32 v50, 16, v48
    v_and_b32 v51, 0xffff0000, v48
    v_lshlrev_b32 v56, 16, v54
    v_and_b32 v57, 0xffff0000, v54
    v_pk_add_f32 v[50:51], v[50:51], v[52:53]
    v_pk_add_f32 v[56:57], v[56:57], v[58:59]
    v_cvt_pk_bf16_f32 v74, v50, v51
    v_cvt_pk_bf16_f32 v75, v56, v57
    buffer_store_dwordx4 v[72:75], v41, s[20:23], s18 offen offset:768 sc1
    v_lshlrev_b32 v52, 16, v76
    v_and_b32 v53, 0xffff0000, v76
    v_lshlrev_b32 v58, 16, v77
    v_and_b32 v59, 0xffff0000, v77
    v_pk_add_f32 v[50:51], v[52:53], v[46:47] op_sel_hi:[1,0] neg_lo:[0,1] neg_hi:[0,1]
    v_pk_add_f32 v[56:57], v[58:59], v[46:47] op_sel_hi:[1,0] neg_lo:[0,1] neg_hi:[0,1]
    v_cvt_pk_bf16_f32 v48, v50, v51
    v_cvt_pk_bf16_f32 v54, v56, v57
    v_lshlrev_b32 v50, 16, v48
    v_and_b32 v51, 0xffff0000, v48
    v_lshlrev_b32 v56, 16, v54
    v_and_b32 v57, 0xffff0000, v54
    v_pk_mul_f32 v[50:51], v[50:51], v[46:47] op_sel:[0,1] op_sel_hi:[1,1]
    v_pk_mul_f32 v[56:57], v[56:57], v[46:47] op_sel:[0,1] op_sel_hi:[1,1]
    v_cvt_pk_bf16_f32 v48, v50, v51
    v_cvt_pk_bf16_f32 v54, v56, v57
    v_lshlrev_b32 v50, 16, v48
    v_and_b32 v51, 0xffff0000, v48
    v_lshlrev_b32 v56, 16, v54
    v_and_b32 v57, 0xffff0000, v54
    v_pk_add_f32 v[50:51], v[50:51], v[52:53]
    v_pk_add_f32 v[56:57], v[56:57], v[58:59]
    v_cvt_pk_bf16_f32 v76, v50, v51
    v_cvt_pk_bf16_f32 v77, v56, v57
    v_lshlrev_b32 v52, 16, v78
    v_and_b32 v53, 0xffff0000, v78
    v_lshlrev_b32 v58, 16, v79
    v_and_b32 v59, 0xffff0000, v79
    v_pk_add_f32 v[50:51], v[52:53], v[46:47] op_sel_hi:[1,0] neg_lo:[0,1] neg_hi:[0,1]
    v_pk_add_f32 v[56:57], v[58:59], v[46:47] op_sel_hi:[1,0] neg_lo:[0,1] neg_hi:[0,1]
    v_cvt_pk_bf16_f32 v48, v50, v51
    v_cvt_pk_bf16_f32 v54, v56, v57
    v_lshlrev_b32 v50, 16, v48
    v_and_b32 v51, 0xffff0000, v48
    v_lshlrev_b32 v56, 16, v54
    v_and_b32 v57, 0xffff0000, v54
    v_pk_mul_f32 v[50:51], v[50:51], v[46:47] op_sel:[0,1] op_sel_hi:[1,1]
    v_pk_mul_f32 v[56:57], v[56:57], v[46:47] op_sel:[0,1] op_sel_hi:[1,1]
    v_cvt_pk_bf16_f32 v48, v50, v51
    v_cvt_pk_bf16_f32 v54, v56, v57
    v_lshlrev_b32 v50, 16, v48
    v_and_b32 v51, 0xffff0000, v48
    v_lshlrev_b32 v56, 16, v54
    v_and_b32 v57, 0xffff0000, v54
    v_pk_add_f32 v[50:51], v[50:51], v[52:53]
    v_pk_add_f32 v[56:57], v[56:57], v[58:59]
    v_cvt_pk_bf16_f32 v78, v50, v51
    v_cvt_pk_bf16_f32 v79, v56, v57
    buffer_store_dwordx4 v[76:79], v41, s[20:23], s18 offen offset:1024 sc1
Lfs_eskip:
    s_branch Lfs_fin
Lfs_down2:
    v_lshlrev_b32 v7, 7, v13
    v_lshl_add_u32 v7, v10, 4, v7
    s_mul_i32 s11, s10, 3072
    s_add_u32 s11, s11, 0x1df0000
    s_add_u32 s11, s11, s51
    s_mov_b32 s15, 0
    buffer_load_dwordx4 v[88:91], v7, s[28:31], s11 offen offset:0 sc1
    buffer_load_dwordx4 v[92:95], v7, s[28:31], s11 offen offset:512 sc1
    buffer_load_dwordx4 v[96:99], v7, s[28:31], s11 offen offset:1024 sc1
    buffer_load_dwordx4 v[100:103], v7, s[28:31], s11 offen offset:1536 sc1
    buffer_load_dwordx4 v[104:107], v7, s[28:31], s11 offen offset:2048 sc1
    buffer_load_dwordx4 v[108:111], v7, s[28:31], s11 offen offset:2560 sc1
Ldph:
    s_mov_b32 s18, 0
    s_waitcnt vmcnt(0)
    v_max3_u32 v8, v88, v89, v90
    v_max_u32 v8, v8, v91
    v_cmp_eq_u32 vcc, -1, v8
    s_cbranch_vccz Ldph_0
    buffer_load_dwordx4 v[88:91], v7, s[28:31], s11 offen offset:0 sc0 sc1
    s_mov_b32 s18, 1
Ldph_0:
    v_max3_u32 v8, v92, v93, v94
    v_max_u32 v8, v8, v95
    v_cmp_eq_u32 vcc, -1, v8
    s_cbranch_vccz Ldph_1
    buffer_load_dwordx4 v[92:95], v7, s[28:31], s11 offen offset:512 sc0 sc1
    s_mov_b32 s18, 1
Ldph_1:
    v_max3_u32 v8, v96, v97, v98
    v_max_u32 v8, v8, v99
    v_cmp_eq_u32 vcc, -1, v8
    s_cbranch_vccz Ldph_2
    buffer_load_dwordx4 v[96:99], v7, s[28:31], s11 offen offset:1024 sc0 sc1
    s_mov_b32 s18, 1
Ldph_2:
    v_max3_u32 v8, v100, v101, v102
    v_max_u32 v8, v8, v103
    v_cmp_eq_u32 vcc, -1, v8
    s_cbranch_vccz Ldph_3
    buffer_load_dwordx4 v[100:103], v7, s[28:31], s11 offen offset:1536 sc0 sc1
    s_mov_b32 s18, 1
Ldph_3:
    v_max3_u32 v8, v104, v105, v106
    v_max_u32 v8, v8, v107
    v_cmp_eq_u32 vcc, -1, v8
    s_cbranch_vccz Ldph_4
    buffer_load_dwordx4 v[104:107], v7, s[28:31], s11 offen offset:2048 sc0 sc1
    s_mov_b32 s18, 1
Ldph_4:
    v_max3_u32 v8, v108, v109, v110
    v_max_u32 v8, v8, v111
    v_cmp_eq_u32 vcc, -1, v8
    s_cbranch_vccz Ldph_5
    buffer_load_dwordx4 v[108:111], v7, s[28:31], s11 offen offset:2560 sc0 sc1
    s_mov_b32 s18, 1
Ldph_5:
    s_cmp_eq_u32 s18, 0
    s_cbranch_scc1 Ldphx
    s_add_u32 s15, s15, 1
    s_cmp_lt_u32 s15, 0x40000
    s_cbranch_scc1 Ldph
    s_waitcnt vmcnt(0)
Ldphx:
    s_waitcnt lgkmcnt(0)
    v_mfma_f32_16x16x32_bf16 v[112:115], v[16:19], v[88:91], 0
    v_mfma_f32_16x16x32_bf16 v[116:119], v[40:43], v[88:91], 0
    v_mfma_f32_16x16x32_bf16 v[120:123], v[64:67], v[88:91], 0
    v_mfma_f32_16x16x32_bf16 v[112:115], v[20:23], v[92:95], v[112:115]
    v_mfma_f32_16x16x32_bf16 v[116:119], v[44:47], v[92:95], v[116:119]
    v_mfma_f32_16x16x32_bf16 v[120:123], v[68:71], v[92:95], v[120:123]
    v_mfma_f32_16x16x32_bf16 v[112:115], v[24:27], v[96:99], v[112:115]
    v_mfma_f32_16x16x32_bf16 v[116:119], v[48:51], v[96:99], v[116:119]
    v_mfma_f32_16x16x32_bf16 v[120:123], v[72:75], v[96:99], v[120:123]
    v_mfma_f32_16x16x32_bf16 v[112:115], v[28:31], v[100:103], v[112:115]
    v_mfma_f32_16x16x32_bf16 v[116:119], v[52:55], v[100:103], v[116:119]
    v_mfma_f32_16x16x32_bf16 v[120:123], v[76:79], v[100:103], v[120:123]
    v_mfma_f32_16x16x32_bf16 v[112:115], v[32:35], v[104:107], v[112:115]
    v_mfma_f32_16x16x32_bf16 v[116:119], v[56:59], v[104:107], v[116:119]
    v_mfma_f32_16x16x32_bf16 v[120:123], v[80:83], v[104:107], v[120:123]
    v_mfma_f32_16x16x32_bf16 v[112:115], v[36:39], v[108:111], v[112:115]
    v_mfma_f32_16x16x32_bf16 v[116:119], v[60:63], v[108:111], v[116:119]
    v_mfma_f32_16x16x32_bf16 v[120:123], v[84:87], v[108:111], v[120:123]
    s_mul_i32 s12, s10, 1536
    v_add_u32 v8, s12, v7
    s_nop 3
    ds_write_b128 v8, v[112:115] offset:0
    ds_write_b128 v8, v[116:119] offset:512
    ds_write_b128 v8, v[120:123] offset:1024
    s_lshl_b32 s12, s10, 9
    v_add_u32 v8, s12, v7
    s_waitcnt lgkmcnt(0)
    s_barrier
    s_cmp_gt_u32 s10, 2
    s_cbranch_scc1 Lfs_fin
    ds_read_b128 v[16:19], v8 offset:0
    ds_read_b128 v[20:23], v8 offset:1536
    ds_read_b128 v[24:27], v8 offset:3072
    ds_read_b128 v[28:31], v8 offset:4608
    ds_read_b128 v[32:35], v8 offset:6144
    ds_read_b128 v[36:39], v8 offset:7680
    ds_read_b128 v[40:43], v8 offset:9216
    ds_read_b128 v[44:47], v8 offset:10752
    v_lshrrev_b32 v7, 1, v13
    v_lshlrev_b32 v7, 7, v7
    v_lshl_add_u32 v7, v10, 4, v7
    s_lshl_b32 s11, s61, 8
    s_add_u32 s11, s11, 0x1df6000
    s_add_u32 s11, s11, s51
    s_waitcnt lgkmcnt(0)
    v_pk_add_f32 v[16:17], v[16:17], v[32:33]
    v_pk_add_f32 v[18:19], v[18:19], v[34:35]
    v_pk_add_f32 v[20:21], v[20:21], v[36:37]
    v_pk_add_f32 v[22:23], v[22:23], v[38:39]
    v_pk_add_f32 v[24:25], v[24:25], v[40:41]
    v_pk_add_f32 v[26:27], v[26:27], v[42:43]
    v_pk_add_f32 v[28:29], v[28:29], v[44:45]
    v_pk_add_f32 v[30:31], v[30:31], v[46:47]
    v_pk_add_f32 v[16:17], v[16:17], v[24:25]
    v_pk_add_f32 v[18:19], v[18:19], v[26:27]
    v_pk_add_f32 v[20:21], v[20:21], v[28:29]
    v_pk_add_f32 v[22:23], v[22:23], v[30:31]
    v_pk_add_f32 v[16:17], v[16:17], v[20:21]
    v_pk_add_f32 v[18:19], v[18:19], v[22:23]
    v_cvt_pk_bf16_f32 v132, v16, v17
    v_lshlrev_b32 v16, 16, v132
    v_and_b32 v17, 0xffff0000, v132
    v_pk_mul_f32 v[16:17], v[16:17], v[136:137] op_sel_hi:[1,0]
    s_nop 0
    v_cvt_pk_bf16_f32 v132, v16, v17
    v_lshlrev_b32 v16, 16, v132
    v_and_b32 v17, 0xffff0000, v132
    v_lshlrev_b32 v134, 16, v138
    v_and_b32 v135, 0xffff0000, v138
    v_pk_add_f32 v[16:17], v[16:17], v[134:135]
    v_cvt_pk_bf16_f32 v132, v16, v17
    v_lshlrev_b32 v16, 16, v132
    v_and_b32 v17, 0xffff0000, v132
    v_pk_add_f32 v[16:17], v[16:17], v[124:125]
    v_cvt_pk_bf16_f32 v128, v16, v17
    v_min_u32 v128, -2, v128
    v_mov_b32 v130, v128
    v_cvt_pk_bf16_f32 v132, v18, v19
    v_lshlrev_b32 v18, 16, v132
    v_and_b32 v19, 0xffff0000, v132
    v_pk_mul_f32 v[18:19], v[18:19], v[136:137] op_sel_hi:[1,0]
    s_nop 0
    v_cvt_pk_bf16_f32 v132, v18, v19
    v_lshlrev_b32 v18, 16, v132
    v_and_b32 v19, 0xffff0000, v132
    v_lshlrev_b32 v134, 16, v139
    v_and_b32 v135, 0xffff0000, v139
    v_pk_add_f32 v[18:19], v[18:19], v[134:135]
    v_cvt_pk_bf16_f32 v132, v18, v19
    v_lshlrev_b32 v18, 16, v132
    v_and_b32 v19, 0xffff0000, v132
    v_pk_add_f32 v[18:19], v[18:19], v[126:127]
    v_cvt_pk_bf16_f32 v129, v18, v19
    v_min_u32 v129, -2, v129
    v_mov_b32 v131, v129
    v_permlane16_swap_b32 v128, v130
    s_nop 0
    v_permlane16_swap_b32 v129, v131
    s_mov_b32 exec_lo, 0xff
    s_mov_b32 exec_hi, 0xff
    s_cmp_eq_u32 s53, 0
    s_cbranch_scc1 Lfs_out
    buffer_store_dwordx4 v[128:131], v7, s[28:31], s11 offen sc1
    s_branch Lfs_fin
Lfs_out:
    buffer_store_dwordx4 v[128:131], v14, s[20:23], s16 offen
    s_branch Lfs_fin
Lfs_fin:
    s_cmp_lg_u32 s53, 0
    s_cbranch_scc1 Lq_fin
Lfs_bye:
Lend:
    s_endpgm
Lfs_w8:
    s_cmp_lg_u32 s53, 0
    s_cbranch_scc1 Lfs_w8a
    s_cmp_lg_u32 s2, 0
    s_cbranch_scc1 Lfs_bye
    v_mov_b32 v2, s98
    v_mov_b32 v3, 0x1ec0800
    s_mov_b64 exec, 1
    buffer_store_dword v2, v3, s[28:31], 0 offen sc1
    s_branch Lfs_bye
Lfs_w8a:
    s_cmp_eq_u32 s13, 62
    s_cbranch_scc1 Lq_fin
    s_cmp_lt_u32 s13, 62
    s_cselect_b32 s11, 1, 2
    s_cmp_lt_u32 s13, 48
    s_cselect_b32 s11, 4, s11
Lfs_w8b:
    s_barrier
    s_sub_u32 s11, s11, 1
    s_cmp_lg_u32 s11, 0
    s_cbranch_scc1 Lfs_w8b
    s_branch Lq_fin
Lcode_end:
    s_endpgm
.section .rodata,"a"
.p2align 6
.amdhsa_kernel interleave_layers__sliding_block__moe_arch_mod__prompt_kernel
  .amdhsa_next_free_vgpr 168
  .amdhsa_next_free_sgpr 102
  .amdhsa_accum_offset 168
  .amdhsa_group_segment_fixed_size 0
  .amdhsa_kernarg_size 88
  .amdhsa_user_sgpr_count 2
  .amdhsa_user_sgpr_kernarg_segment_ptr 1
  .amdhsa_system_sgpr_workgroup_id_x 1
.end_amdhsa_kernel
```
